```python
import torch

def _softmax(x, axis=-1):
    return torch.softmax(x, dim=axis)
def _gelu(x):
    return torch.nn.functional.gelu(x, approximate="tanh")
def _silu(x):
    return torch.nn.functional.silu(x)
def _sigmoid(x):
    return torch.sigmoid(x)
def _layernorm(x, axis=-1, eps=1e-5):
    m = x.mean(dim=axis, keepdim=True)
    v = x.var(dim=axis, keepdim=True, unbiased=False)
    return (x - m) / torch.sqrt(v + eps)
def _scatter_add(tgt, idx, src, axis=0):
    return tgt.clone().index_add_(axis, idx, src)
def _segment_sum(src, seg, n):
    out = torch.zeros((n,) + src.shape[1:], dtype=src.dtype)
    return out.index_add_(0, seg, src)
def _pad(x, pw):
    flat = tuple(v for pair in reversed(pw) for v in pair)
    return torch.nn.functional.pad(x, flat)

kernel_name = 'sequential_preLN__ssm_conv_h3__dense_activation_silu__prompt'

def setup_inputs():

    _w = (lambda a: (lambda t: t.to(torch.bfloat16) if t.is_floating_point() else t)(torch.as_tensor(a)))
    def _A_setup():
        B, S, D = 1, 2048, 512
        ks = 4
        return {
            "q": _w((lambda *s: torch.randn(*s, dtype=torch.bfloat16) * 0.05)(B, S, D)),
            "k": _w((lambda *s: torch.randn(*s, dtype=torch.bfloat16) * 0.2)(B, S, D)),
            "v": _w((lambda *s: torch.randn(*s, dtype=torch.bfloat16) * 0.2)(B, S, D)),
            "shift_k": _w((lambda *s: torch.randn(*s, dtype=torch.bfloat16) * 0.2)(D, ks) * 0.5),
            "ssm_k": _w((lambda *s: torch.randn(*s, dtype=torch.bfloat16) * 0.8)(D, S) * (1.0 / S ** 0.5)),
            "ssm_D": _w((lambda *s: torch.randn(*s, dtype=torch.bfloat16) * 0.2)(D)),
        }
    _A_in = _A_setup()

    def _B_setup():
        B, S, D, F = 1, 2048, 512, 1376
        return {
            "x": _w((lambda *s: torch.randn(*s, dtype=torch.bfloat16) * 0.05)(B, S, D)),
            "w1": _w((lambda *s: torch.randn(*s, dtype=torch.bfloat16) * 0.8)(D, F) * (D ** -0.5)),
            "w2": _w((lambda *s: torch.randn(*s, dtype=torch.bfloat16) * 0.1)(F, D) * (F ** -0.5)),
        }
    _B_in = _B_setup()

    return {
        "A_q": _A_in["q"],
        "A_k": _A_in["k"],
        "A_v": _A_in["v"],
        "A_shift_k": _A_in["shift_k"],
        "A_ssm_k": _A_in["ssm_k"],
        "A_ssm_D": _A_in["ssm_D"],
        "B_x": _B_in["x"],
        "B_w1": _B_in["w1"],
        "B_w2": _B_in["w2"],
    }

def reference(A_q, A_k, A_v, A_shift_k, A_ssm_k, A_ssm_D, B_x, B_w1, B_w2):
    def _A_ref(q, k, v, shift_k, ssm_k, ssm_D):
        B, S, D = q.shape
        ks = shift_k.shape[-1]
        k_pad = _pad(k, ((0, 0), (ks - 1, 0), (0, 0)))
        k_shift = torch.zeros_like(k)
        for t in range(ks):
            k_shift = k_shift + k_pad[:, t:t + S, :] * shift_k[:, ks - 1 - t][None, None, :]
        kv = k_shift * v
        L = 2 * S
        kv_pad = _pad(kv, ((0, 0), (0, S), (0, 0)))
        kf_pad = _pad(ssm_k, ((0, 0), (0, S)))
        kv_f = (lambda x, axes=(-2,-1): torch.fft.rfft2(x.float(), dim=axes))(kv_pad[:, None, :, :], axes=(1, 2))
        kf_f = (lambda x, axes=(-2,-1): torch.fft.rfft2(x.float(), dim=axes))(kf_pad[:, None, :], axes=(1, 2))
        kf_f = (lambda x, *d: x.permute(*d))(kf_f, 1, 2, 0)
        y_f = kv_f * kf_f[None, :, :, :]
        y = (lambda x, s, axes=(-2,-1): torch.fft.irfft2(x, s=s, dim=axes).to(torch.bfloat16))(y_f, (1, L), axes=(1, 2))[:, 0, :S, :]
        y = y + kv * ssm_D[None, None, :]
        return q * y

    def _B_ref(x, w1, w2):
        h = torch.einsum("bsd,df->bsf", x, w1)
        h = _silu(h)
        out = torch.einsum("bsf,fd->bsd", h, w2)
        return out

    x = A_q
    h = x + _A_ref(_layernorm(x, axis=-1), A_k, A_v, A_shift_k, A_ssm_k, A_ssm_D)
    h2 = h + _B_ref(_layernorm(h, axis=-1), B_w1, B_w2)
    return h2
```

```asm
; @launch grid=(256,1,1) block=(512,1,1) lds=163840
.amdgcn_target "amdgcn-amd-amdhsa--gfx950"
.text
.globl sequential_preLN__ssm_conv_h3__dense_activation_silu__prompt_kernel
.p2align 8
.type sequential_preLN__ssm_conv_h3__dense_activation_silu__prompt_kernel,@function
sequential_preLN__ssm_conv_h3__dense_activation_silu__prompt_kernel:
  s_cmp_ge_u32 s2, 256
  s_cbranch_scc1 L_end
  s_load_dwordx8 s[28:35], s[0:1], 0
  s_load_dwordx4 s[36:39], s[0:1], 80
  s_load_dwordx4 s[44:47], s[0:1], 32
  s_load_dwordx4 s[64:67], s[0:1], 56
  s_getpc_b64 s[4:5]
L_pc:
  v_lshlrev_b32 v1, 7, v0
  v_cmp_gt_u32 vcc, L_end-L_pc, v1
  s_and_saveexec_b64 s[6:7], vcc
  s_cbranch_execz L_nopf
  global_load_dword v255, v1, s[4:5]
L_nopf:
  s_mov_b64 exec, -1
  v_lshrrev_b32 v1, 6, v0
  v_and_b32 v2, 63, v0
  s_and_b32 s40, s2, 7
  v_readfirstlane_b32 s42, v1
  s_lshr_b32 s41, s2, 3
  v_lshrrev_b32 v3, 3, v2
  v_and_b32 v4, 7, v2
  v_bfe_u32 v5, v3, 1, 1
  v_xor_b32 v5, v4, v5
  s_and_b32 s43, s42, 3
  s_lshl_b32 s48, s43, 1
  v_xor_b32 v6, 6, v5
  v_xor_b32 v5, s48, v5
  v_lshlrev_b32 v7, 10, v3
  v_lshl_add_u32 v5, v5, 4, v7
  v_lshl_add_u32 v6, v6, 4, v7
  s_lshl_b32 s48, s41, 16
  s_lshl_b32 s49, s40, 7
  s_add_u32 s48, s48, s49
  s_lshl_b32 s49, s43, 13
  s_add_u32 s49, s49, s48
  s_add_u32 s52, s49, 32768
  s_lshl_b32 s51, s43, 10
  v_mov_b32 v30, 0
  v_mov_b32 v31, 0
  v_mov_b32 v32, 0
  v_mov_b32 v33, 0
  v_mov_b32 v34, 51712
  ds_write_b128 v34, v[30:33]
  ds_write_b128 v34, v[30:33] offset:16
  v_mov_b32 v35, 160768
  ds_write_b128 v35, v[30:33]
  ds_write_b128 v35, v[30:33] offset:16
  ds_write_b128 v35, v[30:33] offset:32
  v_lshlrev_b32 v24, 4, v2
  v_mov_b32 v27, 0
  v_mov_b32 v39, 1
  s_mov_b32 s79, 0xffff0000
  s_lshr_b32 s56, s43, 1
  s_and_b32 s57, s43, 1
  s_lshl_b32 s58, s40, 6
  s_lshl_b32 s59, s41, 1
  s_add_u32 s58, s58, s59
  s_add_u32 s59, s58, s56
  s_lshl_b32 s60, s59, 12
  s_mul_i32 s59, s40, 458752
  s_add_u32 s59, s59, s60
  s_mul_i32 s61, s56, 25792
  s_getreg_b32 s101, hwreg(HW_REG_XCC_ID, 0, 4)
  s_add_u32 s101, s101, 1
  s_lshl_b32 s101, s101, 24
  s_cmp_ge_u32 s42, 4
  s_cbranch_scc1 L_B0
  s_add_u32 m0, s51, 66560
  s_waitcnt lgkmcnt(0)
  s_mov_b32 s12, s30
  s_mov_b32 s13, s31
  s_mov_b32 s14, 2097152
  s_mov_b32 s15, 0x00020000
  s_mov_b32 s16, s32
  s_mov_b32 s17, s33
  s_mov_b32 s18, 2097152
  s_mov_b32 s19, 0x00020000
  buffer_load_dwordx4 v5, s[12:15], s49 offen lds
  s_add_u32 m0, s51, 74752
  s_sub_u32 s50, s48, 8192
  buffer_load_dwordx4 v5, s[16:19], s49 offen lds
  s_add_u32 m0, s51, 70656
  s_mov_b32 s20, s34
  buffer_load_dwordx4 v5, s[12:15], s52 offen lds
  s_add_u32 m0, s51, 78848
  s_cmp_eq_u32 s41, 0
  s_cselect_b32 s50, 0x40000000, s50
  buffer_load_dwordx4 v5, s[16:19], s52 offen lds
  s_mov_b32 s21, s35
  s_movk_i32 s22, 4096
  s_mov_b32 s23, 0x00020000
  v_bfe_u32 v11, v2, 4, 1
  v_and_b32 v10, 3, v2
  v_lshl_add_u32 v12, v11, 2, v10
  v_lshlrev_b32 v13, 3, v12
  s_lshl_b32 s53, s40, 9
  s_lshl_b32 s54, s43, 7
  s_add_u32 s53, s53, s54
  buffer_load_dwordx2 v[14:15], v13, s[20:23], s53 offen
  buffer_load_dwordx2 v[16:17], v13, s[20:23], s53 offen offset:64
  s_cmp_lg_u32 s42, 0
  s_cbranch_scc1 L_B0
  s_mov_b32 m0, 65536
  s_mov_b32 exec_lo, 0
  buffer_load_dwordx4 v6, s[12:15], s50 offen lds
  s_mov_b32 exec_lo, -1
L_B0:
  s_waitcnt lgkmcnt(0)
  s_barrier
  s_mov_b32 s24, s38
  s_mov_b32 s25, s39
  s_mov_b32 s26, 268435456
  s_mov_b32 s27, 0x00020000
  s_mov_b32 s68, s36
  s_mov_b32 s69, s37
  s_mov_b32 s70, 256
  s_mov_b32 s71, 0x00020000
  s_cmp_ge_u32 s42, 4
  s_cbranch_scc1 L_B
  s_setprio 3
  v_lshrrev_b32 v8, 4, v2
  v_bfe_u32 v9, v2, 2, 2
  v_and_b32 v10, 3, v2
  v_and_b32 v11, 1, v8
  v_lshl_add_u32 v12, v11, 2, v10
  s_lshr_b32 s72, s42, 2
  s_lshl_b32 s72, s72, 16
  s_add_u32 s72, s72, 6553600
  s_lshl_b32 s62, s40, 2
  s_lshr_b32 s63, s41, 3
  s_add_u32 s63, s63, s62
  s_lshl_b32 s63, s63, 8
  s_add_u32 s63, s63, s72
  s_add_u32 s62, s62, s43
  s_lshl_b32 s62, s62, 5
  s_add_u32 s62, s62, s41
  s_lshl_b32 s62, s62, 3
  s_add_u32 s62, s62, s72
  s_add_u32 s74, s62, 0x8000
  v_and_b32 v25, 31, v2
  v_lshlrev_b32 v25, 3, v25
  buffer_load_dwordx2 v[28:29], v25, s[24:27], s63 offen sc1
  s_lshr_b32 s50, s42, 2
  s_lshl_b32 s50, s50, 18
  s_add_u32 s50, s50, s59
  s_lshl_b32 s72, s57, 11
  s_add_u32 s50, s50, s72
  v_lshlrev_b32 v40, 7, v2
  s_cmp_ge_u32 s42, 4
  s_cselect_b32 s50, 0x40000000, s50
  s_cmp_lt_u32 s42, 4
  s_cselect_b32 s50, 0x40000000, s50
  s_mov_b64 exec, 0xffff
  buffer_load_dword v254, v40, s[24:27], s50 offen
  s_mov_b64 exec, -1
  v_lshrrev_b32 v40, 1, v8
  v_lshl_add_u32 v40, v40, 2, v10
  v_lshl_add_u32 v41, v40, 3, v9
  v_lshlrev_b32 v41, 7, v41
  v_lshl_add_u32 v41, v11, 3, v41
  v_add_u32 v41, 65536, v41
  v_lshrrev_b32 v42, 1, v9
  v_lshl_or_b32 v43, v10, 1, v42
  s_lshl_b32 s50, s43, 1
  v_xor_b32 v43, s50, v43
  v_lshl_add_u32 v43, v43, 4, v41
  v_xor_b32 v45, 16, v43
  v_lshrrev_b32 v47, 1, v8
  v_lshl_add_u32 v47, v47, 2, v9
  v_and_b32 v48, 3, v12
  v_lshlrev_b32 v48, 1, v48
  v_xor_b32 v47, v47, v48
  v_lshlrev_b32 v48, 7, v12
  v_lshl_add_u32 v47, v47, 4, v48
  v_and_b32 v49, 3, v3
  v_lshlrev_b32 v49, 1, v49
  v_xor_b32 v49, v4, v49
  v_lshlrev_b32 v49, 4, v49
  v_lshl_add_u32 v49, v3, 7, v49
  s_lshl_b32 s75, s42, 11
  s_add_u32 s75, s75, 91136
  v_add_u32 v49, s75, v49
  v_lshlrev_b32 v50, 12, v3
  v_lshl_add_u32 v50, v4, 4, v50
  s_mul_i32 s76, s40, 720896
  s_lshl_b32 s77, s43, 16
  s_add_u32 s76, s76, s77
  v_add_u32 v44, 3, v10
  v_and_b32 v44, 3, v44
  v_lshl_or_b32 v44, v44, 1, v42
  s_lshl_b32 s50, s43, 1
  v_xor_b32 v44, s50, v44
  v_lshl_add_u32 v44, v44, 4, v41
  v_xor_b32 v46, 16, v44
  v_xor_b32 v47, 0x70, v47
  v_add_u32 v47, s75, v47
  s_sub_u32 s77, 31, s41
  s_lshl_b32 s77, s77, 7
  s_add_u32 s77, s77, s76
  s_add_u32 s78, s77, 32768
  s_mul_i32 s72, s57, 4576
  s_add_u32 s72, s72, s61
  s_add_u32 s72, s72, 16640
  v_add_u32 v26, s72, v24
  s_mov_b32 exec_lo, 0x0fffffff
  s_mov_b32 exec_hi, 0
  ds_write_b128 v26, v[30:33] offset:4096
  s_mov_b64 exec, -1
  s_lshl_b32 s50, s57, 3
  s_sub_u32 s50, 8, s50
  v_add_u32 v6, s50, v24
  v_and_b32 v13, 15, v2
  v_and_b32 v23, 1, v13
  v_lshrrev_b32 v20, 1, v13
  v_add_u32 v22, v9, v8
  v_mul_u32_u24 v21, 4160, v10
  v_lshl_add_u32 v21, v22, 4, v21
  s_lshl_b32 s73, s57, 8
  s_add_u32 s73, s73, s61
  v_add_u32 v190, s73, v21
  v_mul_u32_u24 v21, 4576, v23
  v_lshl_add_u32 v21, v8, 4, v21
  v_lshlrev_b32 v22, 6, v20
  v_sub_u32 v21, v21, v22
  s_add_u32 s73, s73, 17088
  v_add_u32 v191, s73, v21
  v_and_b32 v21, 3, v20
  v_xor_b32 v21, v8, v21
  v_lshl_add_u32 v21, v20, 2, v21
  v_lshlrev_b32 v21, 5, v21
  v_lshl_add_u32 v21, v23, 4, v21
  s_lshl_b32 s73, s43, 13
  s_add_u32 s73, s73, 133120
  s_cmp_eq_u32 s43, 3
  s_cselect_b32 s73, 53248, s73
  v_add_u32 v192, s73, v21
  s_mov_b32 m0, s72
  s_lshl_b32 s98, s40, 2
  s_lshr_b32 s99, s41, 3
  s_add_u32 s98, s98, s99
  s_and_b32 s99, s41, 7
  s_mul_i32 s100, s99, 11
  s_min_u32 s100, s100, 75
  s_movk_i32 s50, 2979
  v_add_u32 v196, 0, v2
  v_mul_u32_u24 v197, s50, v196
  v_lshrrev_b32 v197, 16, v197
  v_mul_u32_u24 v198, 22, v197
  v_sub_u32 v198, v196, v198
  v_mul_u32_u24 v197, 2752, v197
  v_lshl_add_u32 v193, v198, 4, v197
  v_add_u32 v196, 64, v2
  v_mul_u32_u24 v197, s50, v196
  v_lshrrev_b32 v197, 16, v197
  v_mul_u32_u24 v198, 22, v197
  v_sub_u32 v198, v196, v198
  v_mul_u32_u24 v197, 2752, v197
  v_lshl_add_u32 v194, v198, 4, v197
  v_subrev_u32 v194, 1024, v194
  v_add_u32 v196, 128, v2
  v_mul_u32_u24 v197, s50, v196
  v_lshrrev_b32 v197, 16, v197
  v_mul_u32_u24 v198, 22, v197
  v_sub_u32 v198, v196, v198
  v_mul_u32_u24 v197, 2752, v197
  v_lshl_add_u32 v195, v198, 4, v197
  v_subrev_u32 v195, 2048, v195
  s_lshl_b32 s46, s100, 5
  s_mul_i32 s47, s43, 22016
  s_add_u32 s46, s46, s47
  s_mul_i32 s47, s43, 2816
  s_add_u32 s47, s47, 65536
  s_mov_b32 s8, s64
  s_mov_b32 s9, s65
  s_mov_b32 s10, 1409024
  s_mov_b32 s11, 0x00020000
  s_waitcnt vmcnt(2)
  s_mov_b64 exec, 1
  ds_add_u32 v34, v39 offset:8
  s_mov_b64 exec, -1
  s_add_u32 s12, s38, s59
  s_addc_u32 s13, s39, 0
  s_mov_b32 s14, 4096
  s_mov_b32 s15, 0x00020000
  v_alignbit_b32 v72, v14, v14, 16
  v_alignbit_b32 v73, v15, v15, 16
  v_and_b32 v74, 0xffff, v14
  v_and_b32 v76, s79, v15
  v_and_b32 v75, 0xffff, v15
  v_and_or_b32 v75, v14, s79, v75
  v_alignbit_b32 v78, v16, v16, 16
  v_alignbit_b32 v79, v17, v17, 16
  v_and_b32 v80, 0xffff, v16
  v_and_b32 v82, s79, v17
  v_and_b32 v81, 0xffff, v17
  v_and_or_b32 v81, v16, s79, v81
  s_mov_b32 s3, 0
L_sequential_preLN__ssm_conv_h3__dense_activation_silu__prompt_kernel_1:
  ds_read_b32 v38, v34 offset:8
  s_add_u32 s3, s3, 1
  s_waitcnt lgkmcnt(0)
  v_readfirstlane_b32 s50, v38
  s_cmp_ge_u32 s50, 4
  s_cbranch_scc1 L_sequential_preLN__ssm_conv_h3__dense_activation_silu__prompt_kernel_2
  s_cmp_lt_u32 s3, 2097152
  s_cbranch_scc1 L_sequential_preLN__ssm_conv_h3__dense_activation_silu__prompt_kernel_1
L_sequential_preLN__ssm_conv_h3__dense_activation_silu__prompt_kernel_2:
  buffer_load_dwordx2 v[18:19], v27, s[68:71], 0 offen sc1
  ds_read_b64_tr_b16 v[52:53], v44 offset:512
  ds_read_b64_tr_b16 v[54:55], v43 offset:1024
  ds_read_b64_tr_b16 v[56:57], v43 offset:1536
  ds_read_b64_tr_b16 v[58:59], v43 offset:9216
  ds_read_b64_tr_b16 v[60:61], v43 offset:9728
  ds_read_b64_tr_b16 v[62:63], v46 offset:512
  ds_read_b64_tr_b16 v[64:65], v45 offset:1024
  ds_read_b64_tr_b16 v[66:67], v45 offset:1536
  ds_read_b64_tr_b16 v[68:69], v45 offset:9216
  ds_read_b64_tr_b16 v[70:71], v45 offset:9728
  s_waitcnt lgkmcnt(7)
  v_dot2_f32_bf16 v85, v54, v72, 0
  v_dot2_f32_bf16 v84, v54, v74, 0
  v_dot2_f32_bf16 v87, v55, v72, 0
  v_dot2_f32_bf16 v86, v55, v74, 0
  v_dot2_f32_bf16 v89, v56, v72, 0
  v_dot2_f32_bf16 v88, v56, v74, 0
  v_dot2_f32_bf16 v91, v57, v72, 0
  v_dot2_f32_bf16 v90, v57, v74, 0
  v_dot2_f32_bf16 v85, v53, v73, v85
  v_dot2_f32_bf16 v84, v53, v75, v84
  v_dot2_f32_bf16 v87, v54, v73, v87
  v_dot2_f32_bf16 v86, v54, v75, v86
  v_dot2_f32_bf16 v89, v55, v73, v89
  v_dot2_f32_bf16 v88, v55, v75, v88
  v_dot2_f32_bf16 v91, v56, v73, v91
  v_dot2_f32_bf16 v90, v56, v75, v90
  v_dot2_f32_bf16 v84, v52, v76, v84
  v_dot2_f32_bf16 v86, v53, v76, v86
  v_dot2_f32_bf16 v88, v54, v76, v88
  v_dot2_f32_bf16 v90, v55, v76, v90
  s_waitcnt lgkmcnt(5)
  v_lshlrev_b32 v92, 16, v58
  v_and_b32 v93, s79, v58
  v_lshlrev_b32 v94, 16, v59
  v_and_b32 v95, s79, v59
  v_lshlrev_b32 v96, 16, v60
  v_and_b32 v97, s79, v60
  v_lshlrev_b32 v98, 16, v61
  v_and_b32 v99, s79, v61
  v_pk_mul_f32 v[84:85], v[84:85], v[92:93]
  v_pk_mul_f32 v[86:87], v[86:87], v[94:95]
  v_pk_mul_f32 v[88:89], v[88:89], v[96:97]
  v_pk_mul_f32 v[90:91], v[90:91], v[98:99]
  v_cvt_pk_bf16_f32 v92, v91, v90
  v_cvt_pk_bf16_f32 v93, v89, v88
  v_cvt_pk_bf16_f32 v94, v87, v86
  v_cvt_pk_bf16_f32 v95, v85, v84
  ds_write_b128 v47, v[92:95] offset:0
  ds_read_b128 v[120:123], v49 offset:0
  s_waitcnt lgkmcnt(4)
  v_dot2_f32_bf16 v101, v64, v78, 0
  v_dot2_f32_bf16 v100, v64, v80, 0
  v_dot2_f32_bf16 v103, v65, v78, 0
  v_dot2_f32_bf16 v102, v65, v80, 0
  v_dot2_f32_bf16 v105, v66, v78, 0
  v_dot2_f32_bf16 v104, v66, v80, 0
  v_dot2_f32_bf16 v107, v67, v78, 0
  v_dot2_f32_bf16 v106, v67, v80, 0
  v_dot2_f32_bf16 v101, v63, v79, v101
  v_dot2_f32_bf16 v100, v63, v81, v100
  v_dot2_f32_bf16 v103, v64, v79, v103
  v_dot2_f32_bf16 v102, v64, v81, v102
  v_dot2_f32_bf16 v105, v65, v79, v105
  v_dot2_f32_bf16 v104, v65, v81, v104
  v_dot2_f32_bf16 v107, v66, v79, v107
  v_dot2_f32_bf16 v106, v66, v81, v106
  v_dot2_f32_bf16 v100, v62, v82, v100
  v_dot2_f32_bf16 v102, v63, v82, v102
  v_dot2_f32_bf16 v104, v64, v82, v104
  v_dot2_f32_bf16 v106, v65, v82, v106
  s_waitcnt lgkmcnt(0)
  buffer_store_dwordx4 v[120:123], v50, s[24:27], s77 offen sc1
  v_lshlrev_b32 v108, 16, v68
  v_and_b32 v109, s79, v68
  v_lshlrev_b32 v110, 16, v69
  v_and_b32 v111, s79, v69
  v_lshlrev_b32 v112, 16, v70
  v_and_b32 v113, s79, v70
  v_lshlrev_b32 v114, 16, v71
  v_and_b32 v115, s79, v71
  v_pk_mul_f32 v[100:101], v[100:101], v[108:109]
  v_pk_mul_f32 v[102:103], v[102:103], v[110:111]
  v_pk_mul_f32 v[104:105], v[104:105], v[112:113]
  v_pk_mul_f32 v[106:107], v[106:107], v[114:115]
  v_cvt_pk_bf16_f32 v108, v107, v106
  v_cvt_pk_bf16_f32 v109, v105, v104
  v_cvt_pk_bf16_f32 v110, v103, v102
  v_cvt_pk_bf16_f32 v111, v101, v100
  ds_write_b128 v47, v[108:111] offset:1024
  ds_read_b128 v[124:127], v49 offset:1024
  s_waitcnt lgkmcnt(0)
  buffer_store_dwordx4 v[124:127], v50, s[24:27], s78 offen sc1
  s_mov_b32 s3, 0
  s_waitcnt vmcnt(2)
  s_branch L_sequential_preLN__ssm_conv_h3__dense_activation_silu__prompt_kernel_5
L_sequential_preLN__ssm_conv_h3__dense_activation_silu__prompt_kernel_3:
  buffer_load_dwordx2 v[18:19], v27, s[68:71], 0 offen sc1
  s_add_u32 s3, s3, 1
  s_waitcnt vmcnt(0)
L_sequential_preLN__ssm_conv_h3__dense_activation_silu__prompt_kernel_5:
  v_readfirstlane_b32 s96, v18
  v_readfirstlane_b32 s97, v19
  s_cmp_lg_u32 s97, 0
  s_cbranch_scc1 L_sequential_preLN__ssm_conv_h3__dense_activation_silu__prompt_kernel_4
  s_cmp_lt_u32 s3, 32768
  s_cbranch_scc1 L_sequential_preLN__ssm_conv_h3__dense_activation_silu__prompt_kernel_3
L_sequential_preLN__ssm_conv_h3__dense_activation_silu__prompt_kernel_4:
  s_mov_b32 s44, s96
  s_xor_b32 s45, s97, s101
  v_mov_b32 v18, s44
  v_mov_b32 v19, s45
  s_waitcnt vmcnt(0)
  s_mov_b64 exec, 1
  buffer_store_dwordx2 v[18:19], v27, s[24:27], s62 offen
  ds_add_u32 v34, v39 offset:24
  s_mov_b64 exec, -1
  s_setprio 0
  s_cmp_lg_u32 s43, 0
  s_cbranch_scc1 L_sequential_preLN__ssm_conv_h3__dense_activation_silu__prompt_kernel_9
  s_mov_b32 s22, 0
  s_mov_b64 s[48:49], 0
  s_mov_b32 s23, s63
  s_mov_b64 s[20:21], s[44:45]
  buffer_load_dwordx2 v[28:29], v25, s[24:27], s23 offen sc1
L_sequential_preLN__ssm_conv_h3__dense_activation_silu__prompt_kernel_12:
  buffer_load_dwordx2 v[36:37], v25, s[24:27], s23 offen sc1
  s_waitcnt vmcnt(1)
  v_cmp_eq_u64 vcc, s[20:21], v[28:29]
  s_add_u32 s22, s22, 1
  s_cmp_eq_u64 vcc, -1
  s_cbranch_scc1 L_sequential_preLN__ssm_conv_h3__dense_activation_silu__prompt_kernel_7
  buffer_load_dwordx2 v[28:29], v25, s[24:27], s23 offen sc1
  s_waitcnt vmcnt(1)
  v_cmp_eq_u64 vcc, s[20:21], v[36:37]
  s_cmp_eq_u64 vcc, -1
  s_cbranch_scc1 L_sequential_preLN__ssm_conv_h3__dense_activation_silu__prompt_kernel_7
  s_cmp_lt_u32 s22, 22
  s_cbranch_scc1 L_sequential_preLN__ssm_conv_h3__dense_activation_silu__prompt_kernel_12
L_sequential_preLN__ssm_conv_h3__dense_activation_silu__prompt_kernel_6:
  buffer_load_dwordx2 v[28:29], v25, s[24:27], s23 offen sc1
  s_add_u32 s22, s22, 1
  s_waitcnt vmcnt(0)
  v_cmp_eq_u64 vcc, s[20:21], v[28:29]
  s_or_b64 s[48:49], s[48:49], vcc
  s_cmp_eq_u64 s[48:49], -1
  s_cbranch_scc1 L_sequential_preLN__ssm_conv_h3__dense_activation_silu__prompt_kernel_7
  s_cmp_lt_u32 s22, 24
  s_cbranch_scc1 L_sequential_preLN__ssm_conv_h3__dense_activation_silu__prompt_kernel_6
  s_xor_b32 s23, s23, 0x8000
  s_xor_b32 s21, s21, s101
  s_cmp_lg_u32 s22, 24
  s_cbranch_scc1 L_sequential_preLN__ssm_conv_h3__dense_activation_silu__prompt_kernel_8
  s_mov_b32 s3, 0
L_sequential_preLN__ssm_conv_h3__dense_activation_silu__prompt_kernel_14:
  ds_read_b32 v38, v34 offset:24
  s_add_u32 s3, s3, 1
  s_waitcnt lgkmcnt(0)
  v_readfirstlane_b32 s50, v38
  s_cmp_ge_u32 s50, 4
  s_cbranch_scc1 L_sequential_preLN__ssm_conv_h3__dense_activation_silu__prompt_kernel_15
  s_cmp_lt_u32 s3, 2097152
  s_cbranch_scc1 L_sequential_preLN__ssm_conv_h3__dense_activation_silu__prompt_kernel_14
L_sequential_preLN__ssm_conv_h3__dense_activation_silu__prompt_kernel_15:
  buffer_wbl2 sc1
  s_waitcnt vmcnt(0)
  v_mov_b32 v28, s96
  v_mov_b32 v29, s97
  v_lshlrev_b32 v38, 8, v2
  s_mov_b64 exec, 15
  buffer_store_dwordx2 v[28:29], v38, s[24:27], s74 offen sc1
  s_mov_b64 exec, -1
  s_waitcnt vmcnt(0)
L_sequential_preLN__ssm_conv_h3__dense_activation_silu__prompt_kernel_8:
  s_cmp_lt_u32 s22, 32768
  s_cbranch_scc1 L_sequential_preLN__ssm_conv_h3__dense_activation_silu__prompt_kernel_6
L_sequential_preLN__ssm_conv_h3__dense_activation_silu__prompt_kernel_7:
  s_mov_b64 exec, 1
  ds_add_u32 v34, v39 offset:12
  s_mov_b64 exec, -1
  s_branch L_sequential_preLN__ssm_conv_h3__dense_activation_silu__prompt_kernel_10
L_sequential_preLN__ssm_conv_h3__dense_activation_silu__prompt_kernel_9:
  s_mov_b32 s3, 0
L_sequential_preLN__ssm_conv_h3__dense_activation_silu__prompt_kernel_16:
  ds_read_b32 v38, v34 offset:12
  s_add_u32 s3, s3, 1
  s_waitcnt lgkmcnt(0)
  v_readfirstlane_b32 s50, v38
  s_cmp_ge_u32 s50, 1
  s_cbranch_scc1 L_sequential_preLN__ssm_conv_h3__dense_activation_silu__prompt_kernel_17
  s_cmp_lt_u32 s3, 2097152
  s_cbranch_scc1 L_sequential_preLN__ssm_conv_h3__dense_activation_silu__prompt_kernel_16
L_sequential_preLN__ssm_conv_h3__dense_activation_silu__prompt_kernel_17:
L_sequential_preLN__ssm_conv_h3__dense_activation_silu__prompt_kernel_10:
  buffer_load_dwordx4 v6, s[12:15], 0 offen offset:0 sc1 lds
  buffer_load_dwordx4 v6, s[12:15], 0 offen offset:1024 sc1 lds
  buffer_load_dwordx4 v6, s[12:15], 0 offen offset:2048 sc1 lds
  buffer_load_dwordx4 v6, s[12:15], 0 offen offset:3072 sc1 lds
  s_mov_b32 s3, 0
L_sequential_preLN__ssm_conv_h3__dense_activation_silu__prompt_kernel_18:
  ds_read_b32 v38, v35 offset:32
  s_add_u32 s3, s3, 1
  s_waitcnt lgkmcnt(0)
  v_readfirstlane_b32 s50, v38
  s_cmp_ge_u32 s50, 4
  s_cbranch_scc1 L_sequential_preLN__ssm_conv_h3__dense_activation_silu__prompt_kernel_19
  s_cmp_lt_u32 s3, 2097152
  s_cbranch_scc1 L_sequential_preLN__ssm_conv_h3__dense_activation_silu__prompt_kernel_18
L_sequential_preLN__ssm_conv_h3__dense_activation_silu__prompt_kernel_19:
  ds_read_b128 v[48:51], v190 offset:0
  ds_read_b128 v[52:55], v190 offset:512
  ds_read_b128 v[56:59], v190 offset:1024
  ds_read_b128 v[60:63], v190 offset:1536
  ds_read_b128 v[64:67], v190 offset:2048
  ds_read_b128 v[68:71], v190 offset:2560
  ds_read_b128 v[72:75], v190 offset:3072
  ds_read_b128 v[76:79], v190 offset:3584
  ds_read_b128 v[112:115], v190 offset:64
  ds_read_b128 v[116:119], v190 offset:576
  ds_read_b128 v[120:123], v190 offset:1088
  ds_read_b128 v[124:127], v190 offset:1600
  ds_read_b128 v[128:131], v190 offset:2112
  ds_read_b128 v[132:135], v190 offset:2624
  ds_read_b128 v[136:139], v190 offset:3136
  ds_read_b128 v[140:143], v190 offset:3648
  s_mov_b64 exec, 1
  s_waitcnt vmcnt(0)
  ds_add_u32 v34, v39 offset:4
  s_mov_b64 exec, -1
  s_mov_b32 s3, 0
L_sequential_preLN__ssm_conv_h3__dense_activation_silu__prompt_kernel_20:
  ds_read_b32 v38, v34 offset:4
  s_add_u32 s3, s3, 1
  s_waitcnt lgkmcnt(0)
  v_readfirstlane_b32 s50, v38
  s_cmp_ge_u32 s50, 8
  s_cbranch_scc1 L_sequential_preLN__ssm_conv_h3__dense_activation_silu__prompt_kernel_21
  s_cmp_lt_u32 s3, 2097152
  s_cbranch_scc1 L_sequential_preLN__ssm_conv_h3__dense_activation_silu__prompt_kernel_20
L_sequential_preLN__ssm_conv_h3__dense_activation_silu__prompt_kernel_21:
  s_setprio 3
  ds_read_b128 v[80:83], v191 offset:3584
  ds_read_b128 v[84:87], v191 offset:3072
  ds_read_b128 v[88:91], v191 offset:2560
  ds_read_b128 v[92:95], v191 offset:2048
  ds_read_b128 v[96:99], v191 offset:1536
  ds_read_b128 v[100:103], v191 offset:1024
  ds_read_b128 v[104:107], v191 offset:512
  ds_read_b128 v[108:111], v191 offset:0
  s_waitcnt lgkmcnt(7)
  v_mfma_f32_16x16x32_bf16 v[16:19], v[48:51], v[80:83], 0
  v_mfma_f32_16x16x32_bf16 v[20:23], v[52:55], v[80:83], 0
  v_mfma_f32_16x16x32_bf16 v[24:27], v[56:59], v[80:83], 0
  v_mfma_f32_16x16x32_bf16 v[28:31], v[60:63], v[80:83], 0
  v_mfma_f32_16x16x32_bf16 v[32:35], v[64:67], v[80:83], 0
  v_mfma_f32_16x16x32_bf16 v[36:39], v[68:71], v[80:83], 0
  v_mfma_f32_16x16x32_bf16 v[40:43], v[72:75], v[80:83], 0
  v_mfma_f32_16x16x32_bf16 v[44:47], v[76:79], v[80:83], 0
  s_waitcnt lgkmcnt(6)
  v_mfma_f32_16x16x32_bf16 v[20:23], v[48:51], v[84:87], v[20:23]
  v_mfma_f32_16x16x32_bf16 v[24:27], v[52:55], v[84:87], v[24:27]
  v_mfma_f32_16x16x32_bf16 v[28:31], v[56:59], v[84:87], v[28:31]
  v_mfma_f32_16x16x32_bf16 v[32:35], v[60:63], v[84:87], v[32:35]
  v_mfma_f32_16x16x32_bf16 v[36:39], v[64:67], v[84:87], v[36:39]
  v_mfma_f32_16x16x32_bf16 v[40:43], v[68:71], v[84:87], v[40:43]
  v_mfma_f32_16x16x32_bf16 v[44:47], v[72:75], v[84:87], v[44:47]
  ds_read_b128 v[144:147], v191 offset:3648
  s_waitcnt lgkmcnt(6)
  v_mfma_f32_16x16x32_bf16 v[24:27], v[48:51], v[88:91], v[24:27]
  ds_read_b128 v[148:151], v191 offset:3136
  v_mfma_f32_16x16x32_bf16 v[28:31], v[52:55], v[88:91], v[28:31]
  ds_read_b128 v[152:155], v191 offset:2624
  v_mfma_f32_16x16x32_bf16 v[32:35], v[56:59], v[88:91], v[32:35]
  ds_read_b128 v[156:159], v191 offset:2112
  v_mfma_f32_16x16x32_bf16 v[36:39], v[60:63], v[88:91], v[36:39]
  ds_read_b128 v[160:163], v191 offset:1600
  v_mfma_f32_16x16x32_bf16 v[40:43], v[64:67], v[88:91], v[40:43]
  ds_read_b128 v[164:167], v191 offset:1088
  v_mfma_f32_16x16x32_bf16 v[44:47], v[68:71], v[88:91], v[44:47]
  ds_read_b128 v[168:171], v191 offset:576
  s_waitcnt lgkmcnt(11)
  v_mfma_f32_16x16x32_bf16 v[28:31], v[48:51], v[92:95], v[28:31]
  ds_read_b128 v[172:175], v191 offset:64
  v_mfma_f32_16x16x32_bf16 v[32:35], v[52:55], v[92:95], v[32:35]
  v_mfma_f32_16x16x32_bf16 v[36:39], v[56:59], v[92:95], v[36:39]
  v_mfma_f32_16x16x32_bf16 v[40:43], v[60:63], v[92:95], v[40:43]
  v_mfma_f32_16x16x32_bf16 v[44:47], v[64:67], v[92:95], v[44:47]
  s_waitcnt lgkmcnt(11)
  v_mfma_f32_16x16x32_bf16 v[32:35], v[48:51], v[96:99], v[32:35]
  v_mfma_f32_16x16x32_bf16 v[36:39], v[52:55], v[96:99], v[36:39]
  v_mfma_f32_16x16x32_bf16 v[40:43], v[56:59], v[96:99], v[40:43]
  v_mfma_f32_16x16x32_bf16 v[44:47], v[60:63], v[96:99], v[44:47]
  s_waitcnt lgkmcnt(10)
  v_mfma_f32_16x16x32_bf16 v[36:39], v[48:51], v[100:103], v[36:39]
  v_mfma_f32_16x16x32_bf16 v[40:43], v[52:55], v[100:103], v[40:43]
  v_mfma_f32_16x16x32_bf16 v[44:47], v[56:59], v[100:103], v[44:47]
  s_waitcnt lgkmcnt(9)
  v_mfma_f32_16x16x32_bf16 v[40:43], v[48:51], v[104:107], v[40:43]
  v_mfma_f32_16x16x32_bf16 v[44:47], v[52:55], v[104:107], v[44:47]
  s_waitcnt lgkmcnt(8)
  v_mfma_f32_16x16x32_bf16 v[44:47], v[48:51], v[108:111], v[44:47]
  s_waitcnt lgkmcnt(0)
  v_mfma_f32_16x16x32_bf16 v[16:19], v[112:115], v[144:147], v[16:19]
  ds_read_b128 v[48:51], v190 offset:128
  v_mfma_f32_16x16x32_bf16 v[20:23], v[112:115], v[148:151], v[20:23]
  ds_read_b128 v[80:83], v191 offset:3712
  v_mfma_f32_16x16x32_bf16 v[20:23], v[116:119], v[144:147], v[20:23]
  v_mfma_f32_16x16x32_bf16 v[24:27], v[116:119], v[148:151], v[24:27]
  ds_read_b128 v[52:55], v190 offset:640
  v_mfma_f32_16x16x32_bf16 v[24:27], v[112:115], v[152:155], v[24:27]
  ds_read_b128 v[84:87], v191 offset:3200
  v_mfma_f32_16x16x32_bf16 v[28:31], v[116:119], v[152:155], v[28:31]
  v_mfma_f32_16x16x32_bf16 v[24:27], v[120:123], v[144:147], v[24:27]
  ds_read_b128 v[56:59], v190 offset:1152
  v_mfma_f32_16x16x32_bf16 v[28:31], v[120:123], v[148:151], v[28:31]
  ds_read_b128 v[88:91], v191 offset:2688
  v_mfma_f32_16x16x32_bf16 v[32:35], v[120:123], v[152:155], v[32:35]
  v_mfma_f32_16x16x32_bf16 v[28:31], v[112:115], v[156:159], v[28:31]
  ds_read_b128 v[60:63], v190 offset:1664
  v_mfma_f32_16x16x32_bf16 v[32:35], v[116:119], v[156:159], v[32:35]
  ds_read_b128 v[92:95], v191 offset:2176
  v_mfma_f32_16x16x32_bf16 v[36:39], v[120:123], v[156:159], v[36:39]
  v_mfma_f32_16x16x32_bf16 v[28:31], v[124:127], v[144:147], v[28:31]
  ds_read_b128 v[64:67], v190 offset:2176
  v_mfma_f32_16x16x32_bf16 v[32:35], v[124:127], v[148:151], v[32:35]
  ds_read_b128 v[96:99], v191 offset:1664
  v_mfma_f32_16x16x32_bf16 v[36:39], v[124:127], v[152:155], v[36:39]
  v_mfma_f32_16x16x32_bf16 v[40:43], v[124:127], v[156:159], v[40:43]
  ds_read_b128 v[68:71], v190 offset:2688
  v_mfma_f32_16x16x32_bf16 v[32:35], v[112:115], v[160:163], v[32:35]
  ds_read_b128 v[100:103], v191 offset:1152
  v_mfma_f32_16x16x32_bf16 v[36:39], v[116:119], v[160:163], v[36:39]
  v_mfma_f32_16x16x32_bf16 v[40:43], v[120:123], v[160:163], v[40:43]
  ds_read_b128 v[72:75], v190 offset:3200
  v_mfma_f32_16x16x32_bf16 v[44:47], v[124:127], v[160:163], v[44:47]
  ds_read_b128 v[104:107], v191 offset:640
  v_mfma_f32_16x16x32_bf16 v[32:35], v[128:131], v[144:147], v[32:35]
  v_mfma_f32_16x16x32_bf16 v[36:39], v[128:131], v[148:151], v[36:39]
  ds_read_b128 v[76:79], v190 offset:3712
  v_mfma_f32_16x16x32_bf16 v[40:43], v[128:131], v[152:155], v[40:43]
  ds_read_b128 v[108:111], v191 offset:128
  v_mfma_f32_16x16x32_bf16 v[44:47], v[128:131], v[156:159], v[44:47]
  v_mfma_f32_16x16x32_bf16 v[36:39], v[112:115], v[164:167], v[36:39]
  v_mfma_f32_16x16x32_bf16 v[40:43], v[116:119], v[164:167], v[40:43]
  v_mfma_f32_16x16x32_bf16 v[44:47], v[120:123], v[164:167], v[44:47]
  v_mfma_f32_16x16x32_bf16 v[36:39], v[132:135], v[144:147], v[36:39]
  v_mfma_f32_16x16x32_bf16 v[40:43], v[132:135], v[148:151], v[40:43]
  v_mfma_f32_16x16x32_bf16 v[44:47], v[132:135], v[152:155], v[44:47]
  v_mfma_f32_16x16x32_bf16 v[40:43], v[112:115], v[168:171], v[40:43]
  v_mfma_f32_16x16x32_bf16 v[44:47], v[116:119], v[168:171], v[44:47]
  v_mfma_f32_16x16x32_bf16 v[40:43], v[136:139], v[144:147], v[40:43]
  v_mfma_f32_16x16x32_bf16 v[44:47], v[136:139], v[148:151], v[44:47]
  v_mfma_f32_16x16x32_bf16 v[44:47], v[112:115], v[172:175], v[44:47]
  v_mfma_f32_16x16x32_bf16 v[44:47], v[140:143], v[144:147], v[44:47]
  s_waitcnt lgkmcnt(0)
  v_mfma_f32_16x16x32_bf16 v[16:19], v[48:51], v[80:83], v[16:19]
  ds_read_b128 v[112:115], v190 offset:192
  v_mfma_f32_16x16x32_bf16 v[20:23], v[48:51], v[84:87], v[20:23]
  ds_read_b128 v[144:147], v191 offset:3776
  v_mfma_f32_16x16x32_bf16 v[20:23], v[52:55], v[80:83], v[20:23]
  v_mfma_f32_16x16x32_bf16 v[24:27], v[52:55], v[84:87], v[24:27]
  ds_read_b128 v[116:119], v190 offset:704
  v_mfma_f32_16x16x32_bf16 v[24:27], v[48:51], v[88:91], v[24:27]
  ds_read_b128 v[148:151], v191 offset:3264
  v_mfma_f32_16x16x32_bf16 v[28:31], v[52:55], v[88:91], v[28:31]
  v_mfma_f32_16x16x32_bf16 v[24:27], v[56:59], v[80:83], v[24:27]
  ds_read_b128 v[120:123], v190 offset:1216
  v_mfma_f32_16x16x32_bf16 v[28:31], v[56:59], v[84:87], v[28:31]
  ds_read_b128 v[152:155], v191 offset:2752
  v_mfma_f32_16x16x32_bf16 v[32:35], v[56:59], v[88:91], v[32:35]
  v_mfma_f32_16x16x32_bf16 v[28:31], v[48:51], v[92:95], v[28:31]
  ds_read_b128 v[124:127], v190 offset:1728
  v_mfma_f32_16x16x32_bf16 v[32:35], v[52:55], v[92:95], v[32:35]
  ds_read_b128 v[156:159], v191 offset:2240
  v_mfma_f32_16x16x32_bf16 v[36:39], v[56:59], v[92:95], v[36:39]
  v_mfma_f32_16x16x32_bf16 v[28:31], v[60:63], v[80:83], v[28:31]
  ds_read_b128 v[128:131], v190 offset:2240
  v_mfma_f32_16x16x32_bf16 v[32:35], v[60:63], v[84:87], v[32:35]
  ds_read_b128 v[160:163], v191 offset:1728
  v_mfma_f32_16x16x32_bf16 v[36:39], v[60:63], v[88:91], v[36:39]
  v_mfma_f32_16x16x32_bf16 v[40:43], v[60:63], v[92:95], v[40:43]
  ds_read_b128 v[132:135], v190 offset:2752
  v_mfma_f32_16x16x32_bf16 v[32:35], v[48:51], v[96:99], v[32:35]
  ds_read_b128 v[164:167], v191 offset:1216
  v_mfma_f32_16x16x32_bf16 v[36:39], v[52:55], v[96:99], v[36:39]
  v_mfma_f32_16x16x32_bf16 v[40:43], v[56:59], v[96:99], v[40:43]
  ds_read_b128 v[136:139], v190 offset:3264
  v_mfma_f32_16x16x32_bf16 v[44:47], v[60:63], v[96:99], v[44:47]
  ds_read_b128 v[168:171], v191 offset:704
  v_mfma_f32_16x16x32_bf16 v[32:35], v[64:67], v[80:83], v[32:35]
  v_mfma_f32_16x16x32_bf16 v[36:39], v[64:67], v[84:87], v[36:39]
  ds_read_b128 v[140:143], v190 offset:3776
  v_mfma_f32_16x16x32_bf16 v[40:43], v[64:67], v[88:91], v[40:43]
  ds_read_b128 v[172:175], v191 offset:192
  v_mfma_f32_16x16x32_bf16 v[44:47], v[64:67], v[92:95], v[44:47]
  v_mfma_f32_16x16x32_bf16 v[36:39], v[48:51], v[100:103], v[36:39]
  v_mfma_f32_16x16x32_bf16 v[40:43], v[52:55], v[100:103], v[40:43]
  v_mfma_f32_16x16x32_bf16 v[44:47], v[56:59], v[100:103], v[44:47]
  v_mfma_f32_16x16x32_bf16 v[36:39], v[68:71], v[80:83], v[36:39]
  v_mfma_f32_16x16x32_bf16 v[40:43], v[68:71], v[84:87], v[40:43]
  v_mfma_f32_16x16x32_bf16 v[44:47], v[68:71], v[88:91], v[44:47]
  v_mfma_f32_16x16x32_bf16 v[40:43], v[48:51], v[104:107], v[40:43]
  v_mfma_f32_16x16x32_bf16 v[44:47], v[52:55], v[104:107], v[44:47]
  v_mfma_f32_16x16x32_bf16 v[40:43], v[72:75], v[80:83], v[40:43]
  v_mfma_f32_16x16x32_bf16 v[44:47], v[72:75], v[84:87], v[44:47]
  v_mfma_f32_16x16x32_bf16 v[44:47], v[48:51], v[108:111], v[44:47]
  v_mfma_f32_16x16x32_bf16 v[44:47], v[76:79], v[80:83], v[44:47]
  s_waitcnt lgkmcnt(0)
  v_mfma_f32_16x16x32_bf16 v[16:19], v[112:115], v[144:147], v[16:19]
  v_mfma_f32_16x16x32_bf16 v[20:23], v[112:115], v[148:151], v[20:23]
  v_mfma_f32_16x16x32_bf16 v[20:23], v[116:119], v[144:147], v[20:23]
  v_mfma_f32_16x16x32_bf16 v[24:27], v[112:115], v[152:155], v[24:27]
  v_mfma_f32_16x16x32_bf16 v[24:27], v[116:119], v[148:151], v[24:27]
  v_mfma_f32_16x16x32_bf16 v[24:27], v[120:123], v[144:147], v[24:27]
  v_mfma_f32_16x16x32_bf16 v[28:31], v[112:115], v[156:159], v[28:31]
  v_mfma_f32_16x16x32_bf16 v[28:31], v[116:119], v[152:155], v[28:31]
  v_mfma_f32_16x16x32_bf16 v[28:31], v[120:123], v[148:151], v[28:31]
  ds_write_b128 v192, v[16:19] offset:0
  v_mfma_f32_16x16x32_bf16 v[28:31], v[124:127], v[144:147], v[28:31]
  v_mfma_f32_16x16x32_bf16 v[32:35], v[112:115], v[160:163], v[32:35]
  ds_write_b128 v192, v[20:23] offset:1024
  v_mfma_f32_16x16x32_bf16 v[32:35], v[116:119], v[156:159], v[32:35]
  v_mfma_f32_16x16x32_bf16 v[32:35], v[120:123], v[152:155], v[32:35]
  v_mfma_f32_16x16x32_bf16 v[32:35], v[124:127], v[148:151], v[32:35]
  ds_write_b128 v192, v[24:27] offset:2048
  v_mfma_f32_16x16x32_bf16 v[32:35], v[128:131], v[144:147], v[32:35]
  v_mfma_f32_16x16x32_bf16 v[36:39], v[112:115], v[164:167], v[36:39]
  v_mfma_f32_16x16x32_bf16 v[36:39], v[116:119], v[160:163], v[36:39]
  v_mfma_f32_16x16x32_bf16 v[36:39], v[120:123], v[156:159], v[36:39]
  ds_write_b128 v192, v[28:31] offset:3072
  v_mfma_f32_16x16x32_bf16 v[36:39], v[124:127], v[152:155], v[36:39]
  v_mfma_f32_16x16x32_bf16 v[36:39], v[128:131], v[148:151], v[36:39]
  v_mfma_f32_16x16x32_bf16 v[36:39], v[132:135], v[144:147], v[36:39]
  v_mfma_f32_16x16x32_bf16 v[40:43], v[112:115], v[168:171], v[40:43]
  v_mfma_f32_16x16x32_bf16 v[40:43], v[116:119], v[164:167], v[40:43]
  ds_write_b128 v192, v[32:35] offset:4096
  v_mfma_f32_16x16x32_bf16 v[40:43], v[120:123], v[160:163], v[40:43]
  v_mfma_f32_16x16x32_bf16 v[40:43], v[124:127], v[156:159], v[40:43]
  v_mfma_f32_16x16x32_bf16 v[40:43], v[128:131], v[152:155], v[40:43]
  v_mfma_f32_16x16x32_bf16 v[40:43], v[132:135], v[148:151], v[40:43]
  v_mfma_f32_16x16x32_bf16 v[40:43], v[136:139], v[144:147], v[40:43]
  v_mfma_f32_16x16x32_bf16 v[44:47], v[112:115], v[172:175], v[44:47]
  ds_write_b128 v192, v[36:39] offset:5120
  v_mfma_f32_16x16x32_bf16 v[44:47], v[116:119], v[168:171], v[44:47]
  v_mfma_f32_16x16x32_bf16 v[44:47], v[120:123], v[164:167], v[44:47]
  v_mfma_f32_16x16x32_bf16 v[44:47], v[124:127], v[160:163], v[44:47]
  v_mfma_f32_16x16x32_bf16 v[44:47], v[128:131], v[156:159], v[44:47]
  v_mfma_f32_16x16x32_bf16 v[44:47], v[132:135], v[152:155], v[44:47]
  v_mfma_f32_16x16x32_bf16 v[44:47], v[136:139], v[148:151], v[44:47]
  v_mfma_f32_16x16x32_bf16 v[44:47], v[140:143], v[144:147], v[44:47]
  ds_write_b128 v192, v[40:43] offset:6144
  s_nop 7
  ds_write_b128 v192, v[44:47] offset:7168
  s_waitcnt lgkmcnt(0)
  s_barrier
  s_setprio 0
  s_load_dwordx2 s[32:33], s[0:1], 72
  v_and_b32 v5, 6, v3
  v_xor_b32 v5, v4, v5
  v_lshlrev_b32 v3, 7, v3
  v_lshl_add_u32 v3, v5, 4, v3
  s_lshl_b32 s49, s42, 10
  s_lshl_b32 s48, s98, 16
  s_add_u32 s48, s48, s49
  s_add_u32 s48, s48, 7340032
  v_lshl_add_u32 v5, v8, 2, v9
  v_mul_u32_u24 v16, 352, v5
  v_lshl_add_u32 v16, v10, 3, v16
  s_mul_i32 s54, s43, 96
  s_add_u32 s54, s54, 65536
  v_add_u32 v16, s54, v16
  v_add_u32 v17, 45056, v16
  v_bfe_u32 v18, v5, 1, 2
  v_xor_b32 v18, s43, v18
  v_lshlrev_b32 v19, 7, v5
  v_lshl_add_u32 v19, v10, 3, v19
  v_lshl_add_u32 v18, v18, 5, v19
  v_xor_b32 v19, 32, v18
  v_xor_b32 v20, 64, v18
  v_xor_b32 v21, 96, v18
  v_lshrrev_b32 v5, 1, v8
  v_and_b32 v6, 15, v2
  v_lshl_add_u32 v5, v5, 4, v6
  v_xor_b32 v22, s43, v11
  v_xor_b32 v23, 2, v22
  v_mul_u32_u24 v22, 44032, v22
  v_mul_u32_u24 v23, 44032, v23
  v_lshl_add_u32 v22, v5, 4, v22
  v_lshl_add_u32 v23, v5, 4, v23
  s_mul_i32 s52, s43, 3
  s_add_u32 s52, s52, s100
  s_lshr_b32 s58, s41, 3
  s_mul_i32 s58, s58, 344
  s_add_u32 s58, s58, s52
  s_lshl_b32 s58, s58, 9
  s_mul_i32 s54, s40, 720896
  s_add_u32 s58, s58, s54
  s_cmp_eq_u32 s43, 3
  s_cselect_b32 s60, 0x40000000, s58
  s_lshl_b32 s54, s43, 8
  s_add_u32 s54, s54, 159744
  v_lshlrev_b32 v24, 4, v6
  v_add_u32 v24, s54, v24
  v_xor_b32 v25, 256, v24
  v_xor_b32 v26, 512, v24
  v_xor_b32 v27, 768, v24
  v_mov_b32 v7, 0
  s_lshl_b32 s53, s98, 9
  s_add_u32 s53, s53, 6815744
  s_lshl_b32 s54, s99, 5
  s_add_u32 s53, s53, s54
  s_lshl_b32 s54, s43, 3
  s_add_u32 s53, s53, s54
  v_mov_b32 v40, 0x3f803f80
  v_mov_b32 v41, 0x3f803f80
  v_mov_b32 v42, 0x3f803f80
  v_mov_b32 v43, 0x3f803f80
  s_waitcnt lgkmcnt(0)
  s_mov_b32 s16, s32
  s_mov_b32 s17, s33
  s_mov_b32 s18, 2097152
  s_mov_b32 s19, 0x00020000
  s_lshl_b32 s66, s57, 1
  s_add_u32 s66, s66, s56
  v_lshl_add_u32 v5, v8, 2, v9
  v_bfe_u32 v6, v5, 1, 2
  v_xor_b32 v6, s66, v6
  v_lshlrev_b32 v5, 7, v5
  v_lshl_add_u32 v5, v10, 3, v5
  v_lshl_add_u32 v5, v6, 5, v5
  s_lshl_b32 s54, s99, 13
  v_add_u32 v12, s54, v5
  v_mov_b32 v1, 160768
  v_mov_b32 v4, 1
  s_barrier
  s_add_u32 m0, s47, 67584
  s_add_u32 s51, s46, 528384
  buffer_load_dwordx4 v193, s[8:11], s51 offen lds
  buffer_load_dwordx4 v194, s[8:11], s51 offen offset:1024 lds
  s_mov_b32 exec_hi, 0xffff
  buffer_load_dwordx4 v195, s[8:11], s51 offen offset:2048 lds
  s_mov_b32 exec_hi, -1
  s_add_u32 m0, s47, 78848
  s_add_u32 s51, s46, 616448
  buffer_load_dwordx4 v193, s[8:11], s51 offen lds
  buffer_load_dwordx4 v194, s[8:11], s51 offen offset:1024 lds
  s_mov_b32 exec_hi, 0xffff
  buffer_load_dwordx4 v195, s[8:11], s51 offen offset:2048 lds
  s_mov_b32 exec_hi, -1
  ds_read_b64_tr_b16 v[88:89], v16 offset:0
  ds_read_b64_tr_b16 v[90:91], v16 offset:5632
  ds_read_b64_tr_b16 v[92:93], v16 offset:32
  ds_read_b64_tr_b16 v[94:95], v16 offset:5664
  ds_read_b64_tr_b16 v[96:97], v16 offset:64
  ds_read_b64_tr_b16 v[98:99], v16 offset:5696
  ds_read_b64_tr_b16 v[100:101], v16 offset:11264
  ds_read_b64_tr_b16 v[102:103], v16 offset:16896
  ds_read_b64_tr_b16 v[104:105], v16 offset:11296
  ds_read_b64_tr_b16 v[106:107], v16 offset:16928
  ds_read_b64_tr_b16 v[108:109], v16 offset:11328
  ds_read_b64_tr_b16 v[110:111], v16 offset:16960
  ds_read_b64_tr_b16 v[112:113], v16 offset:22528
  ds_read_b64_tr_b16 v[114:115], v16 offset:28160
  ds_read_b64_tr_b16 v[116:117], v16 offset:22560
  ds_read_b64_tr_b16 v[118:119], v16 offset:28192
  ds_read_b64_tr_b16 v[120:121], v16 offset:22592
  ds_read_b64_tr_b16 v[122:123], v16 offset:28224
  ds_read_b64_tr_b16 v[124:125], v16 offset:33792
  ds_read_b64_tr_b16 v[126:127], v16 offset:39424
  ds_read_b64_tr_b16 v[128:129], v16 offset:33824
  ds_read_b64_tr_b16 v[130:131], v16 offset:39456
  ds_read_b64_tr_b16 v[132:133], v16 offset:33856
  ds_read_b64_tr_b16 v[134:135], v16 offset:39488
  s_waitcnt lgkmcnt(0)
  s_mov_b64 exec, 1
  ds_add_u32 v1, v4 offset:16
  s_mov_b64 exec, -1
  s_mov_b32 s3, 0
L_sequential_preLN__ssm_conv_h3__dense_activation_silu__prompt_kernel_22:
  ds_read_b32 v5, v1 offset:16
  s_add_u32 s3, s3, 1
  s_waitcnt lgkmcnt(0)
  v_readfirstlane_b32 s50, v5
  s_cmp_ge_u32 s50, 4
  s_cbranch_scc1 L_sequential_preLN__ssm_conv_h3__dense_activation_silu__prompt_kernel_23
  s_cmp_lt_u32 s3, 2097152
  s_cbranch_scc1 L_sequential_preLN__ssm_conv_h3__dense_activation_silu__prompt_kernel_22
L_sequential_preLN__ssm_conv_h3__dense_activation_silu__prompt_kernel_23:
  s_add_u32 m0, s47, 0
  s_add_u32 s51, s46, 704512
  buffer_load_dwordx4 v193, s[8:11], s51 offen lds
  buffer_load_dwordx4 v194, s[8:11], s51 offen offset:1024 lds
  s_mov_b32 exec_hi, 0xffff
  buffer_load_dwordx4 v195, s[8:11], s51 offen offset:2048 lds
  s_mov_b32 exec_hi, -1
  s_add_u32 m0, s47, 11264
  s_add_u32 s51, s46, 792576
  buffer_load_dwordx4 v193, s[8:11], s51 offen lds
  buffer_load_dwordx4 v194, s[8:11], s51 offen offset:1024 lds
  s_mov_b32 exec_hi, 0xffff
  buffer_load_dwordx4 v195, s[8:11], s51 offen offset:2048 lds
  s_mov_b32 exec_hi, -1
  s_add_u32 m0, s47, 22528
  s_add_u32 s51, s46, 880640
  buffer_load_dwordx4 v193, s[8:11], s51 offen lds
  buffer_load_dwordx4 v194, s[8:11], s51 offen offset:1024 lds
  s_mov_b32 exec_hi, 0xffff
  buffer_load_dwordx4 v195, s[8:11], s51 offen offset:2048 lds
  s_mov_b32 exec_hi, -1
  s_add_u32 m0, s47, 33792
  s_add_u32 s51, s46, 968704
  buffer_load_dwordx4 v193, s[8:11], s51 offen lds
  buffer_load_dwordx4 v194, s[8:11], s51 offen offset:1024 lds
  s_mov_b32 exec_hi, 0xffff
  buffer_load_dwordx4 v195, s[8:11], s51 offen offset:2048 lds
  s_mov_b32 exec_hi, -1
  v_mfma_f32_16x16x32_bf16 v[28:31], v[88:91], v[40:43], 0
  v_mfma_f32_16x16x32_bf16 v[32:35], v[92:95], v[40:43], 0
  v_mfma_f32_16x16x32_bf16 v[36:39], v[96:99], v[40:43], 0
  v_mfma_f32_16x16x32_bf16 v[28:31], v[100:103], v[40:43], v[28:31]
  v_mfma_f32_16x16x32_bf16 v[32:35], v[104:107], v[40:43], v[32:35]
  v_mfma_f32_16x16x32_bf16 v[36:39], v[108:111], v[40:43], v[36:39]
  v_mfma_f32_16x16x32_bf16 v[28:31], v[112:115], v[40:43], v[28:31]
  v_mfma_f32_16x16x32_bf16 v[32:35], v[116:119], v[40:43], v[32:35]
  v_mfma_f32_16x16x32_bf16 v[36:39], v[120:123], v[40:43], v[36:39]
  v_mfma_f32_16x16x32_bf16 v[28:31], v[124:127], v[40:43], v[28:31]
  v_mfma_f32_16x16x32_bf16 v[32:35], v[128:131], v[40:43], v[32:35]
  v_mfma_f32_16x16x32_bf16 v[36:39], v[132:135], v[40:43], v[36:39]
  s_waitcnt vmcnt(12)
  s_mov_b64 exec, 1
  ds_add_u32 v1, v4 offset:16
  s_mov_b64 exec, -1
  s_mov_b32 s3, 0
L_sequential_preLN__ssm_conv_h3__dense_activation_silu__prompt_kernel_24:
  ds_read_b32 v5, v1 offset:16
  s_add_u32 s3, s3, 1
  s_waitcnt lgkmcnt(0)
  v_readfirstlane_b32 s50, v5
  s_cmp_ge_u32 s50, 8
  s_cbranch_scc1 L_sequential_preLN__ssm_conv_h3__dense_activation_silu__prompt_kernel_25
  s_cmp_lt_u32 s3, 2097152
  s_cbranch_scc1 L_sequential_preLN__ssm_conv_h3__dense_activation_silu__prompt_kernel_24
L_sequential_preLN__ssm_conv_h3__dense_activation_silu__prompt_kernel_25:
  ds_read_b64_tr_b16 v[136:137], v17 offset:0
  ds_read_b64_tr_b16 v[138:139], v17 offset:5632
  ds_read_b64_tr_b16 v[140:141], v17 offset:32
  ds_read_b64_tr_b16 v[142:143], v17 offset:5664
  ds_read_b64_tr_b16 v[144:145], v17 offset:64
  ds_read_b64_tr_b16 v[146:147], v17 offset:5696
  ds_read_b64_tr_b16 v[148:149], v17 offset:11264
  ds_read_b64_tr_b16 v[150:151], v17 offset:16896
  ds_read_b64_tr_b16 v[152:153], v17 offset:11296
  ds_read_b64_tr_b16 v[154:155], v17 offset:16928
  ds_read_b64_tr_b16 v[156:157], v17 offset:11328
  ds_read_b64_tr_b16 v[158:159], v17 offset:16960
  ds_read_b64_tr_b16 v[160:161], v17 offset:22528
  ds_read_b64_tr_b16 v[162:163], v17 offset:28160
  ds_read_b64_tr_b16 v[164:165], v17 offset:22560
  ds_read_b64_tr_b16 v[166:167], v17 offset:28192
  ds_read_b64_tr_b16 v[168:169], v17 offset:22592
  ds_read_b64_tr_b16 v[170:171], v17 offset:28224
  ds_read_b64_tr_b16 v[172:173], v17 offset:33792
  ds_read_b64_tr_b16 v[174:175], v17 offset:39424
  ds_read_b64_tr_b16 v[176:177], v17 offset:33824
  ds_read_b64_tr_b16 v[178:179], v17 offset:39456
  ds_read_b64_tr_b16 v[180:181], v17 offset:33856
  ds_read_b64_tr_b16 v[182:183], v17 offset:39488
  s_waitcnt lgkmcnt(0)
  s_mov_b64 exec, 1
  ds_add_u32 v1, v4 offset:16
  s_mov_b64 exec, -1
  s_mov_b32 s3, 0
L_sequential_preLN__ssm_conv_h3__dense_activation_silu__prompt_kernel_26:
  ds_read_b32 v5, v1 offset:16
  s_add_u32 s3, s3, 1
  s_waitcnt lgkmcnt(0)
  v_readfirstlane_b32 s50, v5
  s_cmp_ge_u32 s50, 12
  s_cbranch_scc1 L_sequential_preLN__ssm_conv_h3__dense_activation_silu__prompt_kernel_27
  s_cmp_lt_u32 s3, 2097152
  s_cbranch_scc1 L_sequential_preLN__ssm_conv_h3__dense_activation_silu__prompt_kernel_26
L_sequential_preLN__ssm_conv_h3__dense_activation_silu__prompt_kernel_27:
  s_add_u32 m0, s47, 45056
  s_add_u32 s51, s46, 1056768
  buffer_load_dwordx4 v193, s[8:11], s51 offen lds
  buffer_load_dwordx4 v194, s[8:11], s51 offen offset:1024 lds
  s_mov_b32 exec_hi, 0xffff
  buffer_load_dwordx4 v195, s[8:11], s51 offen offset:2048 lds
  s_mov_b32 exec_hi, -1
  s_add_u32 m0, s47, 56320
  s_add_u32 s51, s46, 1144832
  buffer_load_dwordx4 v193, s[8:11], s51 offen lds
  buffer_load_dwordx4 v194, s[8:11], s51 offen offset:1024 lds
  s_mov_b32 exec_hi, 0xffff
  buffer_load_dwordx4 v195, s[8:11], s51 offen offset:2048 lds
  s_mov_b32 exec_hi, -1
  s_add_u32 m0, s47, 67584
  s_add_u32 s51, s46, 1232896
  buffer_load_dwordx4 v193, s[8:11], s51 offen lds
  buffer_load_dwordx4 v194, s[8:11], s51 offen offset:1024 lds
  s_mov_b32 exec_hi, 0xffff
  buffer_load_dwordx4 v195, s[8:11], s51 offen offset:2048 lds
  s_mov_b32 exec_hi, -1
  s_add_u32 m0, s47, 78848
  s_add_u32 s51, s46, 1320960
  buffer_load_dwordx4 v193, s[8:11], s51 offen lds
  buffer_load_dwordx4 v194, s[8:11], s51 offen offset:1024 lds
  s_mov_b32 exec_hi, 0xffff
  buffer_load_dwordx4 v195, s[8:11], s51 offen offset:2048 lds
  s_mov_b32 exec_hi, -1
  v_mfma_f32_16x16x32_bf16 v[28:31], v[136:139], v[40:43], v[28:31]
  v_mfma_f32_16x16x32_bf16 v[32:35], v[140:143], v[40:43], v[32:35]
  v_mfma_f32_16x16x32_bf16 v[36:39], v[144:147], v[40:43], v[36:39]
  v_mfma_f32_16x16x32_bf16 v[28:31], v[148:151], v[40:43], v[28:31]
  v_mfma_f32_16x16x32_bf16 v[32:35], v[152:155], v[40:43], v[32:35]
  v_mfma_f32_16x16x32_bf16 v[36:39], v[156:159], v[40:43], v[36:39]
  v_mfma_f32_16x16x32_bf16 v[28:31], v[160:163], v[40:43], v[28:31]
  v_mfma_f32_16x16x32_bf16 v[32:35], v[164:167], v[40:43], v[32:35]
  v_mfma_f32_16x16x32_bf16 v[36:39], v[168:171], v[40:43], v[36:39]
  v_mfma_f32_16x16x32_bf16 v[28:31], v[172:175], v[40:43], v[28:31]
  v_mfma_f32_16x16x32_bf16 v[32:35], v[176:179], v[40:43], v[32:35]
  v_mfma_f32_16x16x32_bf16 v[36:39], v[180:183], v[40:43], v[36:39]
  s_waitcnt vmcnt(12)
  s_mov_b64 exec, 1
  ds_add_u32 v1, v4 offset:16
  s_mov_b64 exec, -1
  s_mov_b32 s3, 0
L_sequential_preLN__ssm_conv_h3__dense_activation_silu__prompt_kernel_28:
  ds_read_b32 v5, v1 offset:16
  s_add_u32 s3, s3, 1
  s_waitcnt lgkmcnt(0)
  v_readfirstlane_b32 s50, v5
  s_cmp_ge_u32 s50, 16
  s_cbranch_scc1 L_sequential_preLN__ssm_conv_h3__dense_activation_silu__prompt_kernel_29
  s_cmp_lt_u32 s3, 2097152
  s_cbranch_scc1 L_sequential_preLN__ssm_conv_h3__dense_activation_silu__prompt_kernel_28
L_sequential_preLN__ssm_conv_h3__dense_activation_silu__prompt_kernel_29:
  ds_read_b64_tr_b16 v[208:209], v16 offset:0
  ds_read_b64_tr_b16 v[210:211], v16 offset:5632
  ds_read_b64_tr_b16 v[212:213], v16 offset:32
  ds_read_b64_tr_b16 v[214:215], v16 offset:5664
  ds_read_b64_tr_b16 v[216:217], v16 offset:64
  ds_read_b64_tr_b16 v[218:219], v16 offset:5696
  ds_read_b64_tr_b16 v[220:221], v16 offset:11264
  ds_read_b64_tr_b16 v[222:223], v16 offset:16896
  ds_read_b64_tr_b16 v[224:225], v16 offset:11296
  ds_read_b64_tr_b16 v[226:227], v16 offset:16928
  ds_read_b64_tr_b16 v[228:229], v16 offset:11328
  ds_read_b64_tr_b16 v[230:231], v16 offset:16960
  ds_read_b64_tr_b16 v[232:233], v16 offset:22528
  ds_read_b64_tr_b16 v[234:235], v16 offset:28160
  ds_read_b64_tr_b16 v[236:237], v16 offset:22560
  ds_read_b64_tr_b16 v[238:239], v16 offset:28192
  ds_read_b64_tr_b16 v[240:241], v16 offset:22592
  ds_read_b64_tr_b16 v[242:243], v16 offset:28224
  ds_read_b64_tr_b16 v[244:245], v16 offset:33792
  ds_read_b64_tr_b16 v[246:247], v16 offset:39424
  ds_read_b64_tr_b16 v[248:249], v16 offset:33824
  ds_read_b64_tr_b16 v[250:251], v16 offset:39456
  ds_read_b64_tr_b16 v[252:253], v16 offset:33856
  ds_read_b64_tr_b16 v[254:255], v16 offset:39488
  s_waitcnt lgkmcnt(0)
  v_mfma_f32_16x16x32_bf16 v[28:31], v[208:211], v[40:43], v[28:31]
  v_mfma_f32_16x16x32_bf16 v[32:35], v[212:215], v[40:43], v[32:35]
  v_mfma_f32_16x16x32_bf16 v[36:39], v[216:219], v[40:43], v[36:39]
  v_mfma_f32_16x16x32_bf16 v[28:31], v[220:223], v[40:43], v[28:31]
  v_mfma_f32_16x16x32_bf16 v[32:35], v[224:227], v[40:43], v[32:35]
  v_mfma_f32_16x16x32_bf16 v[36:39], v[228:231], v[40:43], v[36:39]
  v_mfma_f32_16x16x32_bf16 v[28:31], v[232:235], v[40:43], v[28:31]
  v_mfma_f32_16x16x32_bf16 v[32:35], v[236:239], v[40:43], v[32:35]
  v_mfma_f32_16x16x32_bf16 v[36:39], v[240:243], v[40:43], v[36:39]
  v_mfma_f32_16x16x32_bf16 v[28:31], v[244:247], v[40:43], v[28:31]
  v_mfma_f32_16x16x32_bf16 v[32:35], v[248:251], v[40:43], v[32:35]
  v_mfma_f32_16x16x32_bf16 v[36:39], v[252:255], v[40:43], v[36:39]
  s_setprio 1
  s_barrier
  s_add_u32 m0, s49, 32768
  s_add_u32 s51, s48, 32768
  buffer_load_dwordx4 v3, s[24:27], s51 offen sc1 lds
  s_add_u32 m0, s49, 40960
  s_add_u32 s51, s48, 40960
  buffer_load_dwordx4 v3, s[24:27], s51 offen sc1 lds
  s_add_u32 m0, s49, 49152
  s_add_u32 s51, s48, 49152
  buffer_load_dwordx4 v3, s[24:27], s51 offen sc1 lds
  s_add_u32 m0, s49, 57344
  s_add_u32 s51, s48, 57344
  buffer_load_dwordx4 v3, s[24:27], s51 offen sc1 lds
  s_add_u32 m0, s49, 0
  s_add_u32 s51, s48, 0
  buffer_load_dwordx4 v3, s[24:27], s51 offen sc1 lds
  s_add_u32 m0, s49, 8192
  s_add_u32 s51, s48, 8192
  buffer_load_dwordx4 v3, s[24:27], s51 offen sc1 lds
  s_add_u32 m0, s49, 16384
  s_add_u32 s51, s48, 16384
  buffer_load_dwordx4 v3, s[24:27], s51 offen sc1 lds
  s_add_u32 m0, s49, 24576
  s_add_u32 s51, s48, 24576
  buffer_load_dwordx4 v3, s[24:27], s51 offen sc1 lds
  s_waitcnt vmcnt(8)
  s_mov_b64 exec, 1
  ds_add_u32 v1, v4 offset:16
  s_mov_b64 exec, -1
  s_mov_b32 s3, 0
L_sequential_preLN__ssm_conv_h3__dense_activation_silu__prompt_kernel_30:
  ds_read_b32 v5, v1 offset:16
  s_add_u32 s3, s3, 1
  s_waitcnt lgkmcnt(0)
  v_readfirstlane_b32 s50, v5
  s_cmp_ge_u32 s50, 20
  s_cbranch_scc1 L_sequential_preLN__ssm_conv_h3__dense_activation_silu__prompt_kernel_31
  s_cmp_lt_u32 s3, 2097152
  s_cbranch_scc1 L_sequential_preLN__ssm_conv_h3__dense_activation_silu__prompt_kernel_30
L_sequential_preLN__ssm_conv_h3__dense_activation_silu__prompt_kernel_31:
  ds_read_b64_tr_b16 v[208:209], v17 offset:0
  ds_read_b64_tr_b16 v[210:211], v17 offset:5632
  ds_read_b64_tr_b16 v[212:213], v17 offset:32
  ds_read_b64_tr_b16 v[214:215], v17 offset:5664
  ds_read_b64_tr_b16 v[216:217], v17 offset:64
  ds_read_b64_tr_b16 v[218:219], v17 offset:5696
  ds_read_b64_tr_b16 v[220:221], v17 offset:11264
  ds_read_b64_tr_b16 v[222:223], v17 offset:16896
  ds_read_b64_tr_b16 v[224:225], v17 offset:11296
  ds_read_b64_tr_b16 v[226:227], v17 offset:16928
  ds_read_b64_tr_b16 v[228:229], v17 offset:11328
  ds_read_b64_tr_b16 v[230:231], v17 offset:16960
  ds_read_b64_tr_b16 v[232:233], v17 offset:22528
  ds_read_b64_tr_b16 v[234:235], v17 offset:28160
  ds_read_b64_tr_b16 v[236:237], v17 offset:22560
  ds_read_b64_tr_b16 v[238:239], v17 offset:28192
  ds_read_b64_tr_b16 v[240:241], v17 offset:22592
  ds_read_b64_tr_b16 v[242:243], v17 offset:28224
  ds_read_b64_tr_b16 v[244:245], v17 offset:33792
  ds_read_b64_tr_b16 v[246:247], v17 offset:39424
  ds_read_b64_tr_b16 v[248:249], v17 offset:33824
  ds_read_b64_tr_b16 v[250:251], v17 offset:39456
  ds_read_b64_tr_b16 v[252:253], v17 offset:33856
  ds_read_b64_tr_b16 v[254:255], v17 offset:39488
  s_waitcnt lgkmcnt(0)
  v_mfma_f32_16x16x32_bf16 v[28:31], v[208:211], v[40:43], v[28:31]
  v_mfma_f32_16x16x32_bf16 v[32:35], v[212:215], v[40:43], v[32:35]
  v_mfma_f32_16x16x32_bf16 v[36:39], v[216:219], v[40:43], v[36:39]
  v_mfma_f32_16x16x32_bf16 v[28:31], v[220:223], v[40:43], v[28:31]
  v_mfma_f32_16x16x32_bf16 v[32:35], v[224:227], v[40:43], v[32:35]
  v_mfma_f32_16x16x32_bf16 v[36:39], v[228:231], v[40:43], v[36:39]
  v_mfma_f32_16x16x32_bf16 v[28:31], v[232:235], v[40:43], v[28:31]
  v_mfma_f32_16x16x32_bf16 v[32:35], v[236:239], v[40:43], v[32:35]
  v_mfma_f32_16x16x32_bf16 v[36:39], v[240:243], v[40:43], v[36:39]
  v_mfma_f32_16x16x32_bf16 v[28:31], v[244:247], v[40:43], v[28:31]
  v_mfma_f32_16x16x32_bf16 v[32:35], v[248:251], v[40:43], v[32:35]
  v_mfma_f32_16x16x32_bf16 v[36:39], v[252:255], v[40:43], v[36:39]
  ds_read_b64_tr_b16 v[184:185], v16 offset:0
  ds_read_b64_tr_b16 v[186:187], v16 offset:5632
  ds_read_b64_tr_b16 v[188:189], v16 offset:32
  ds_read_b64_tr_b16 v[190:191], v16 offset:5664
  ds_read_b64_tr_b16 v[192:193], v16 offset:64
  ds_read_b64_tr_b16 v[194:195], v16 offset:5696
  s_waitcnt vmcnt(6)
  s_barrier
  ds_read_b64_tr_b16 v[208:209], v18 offset:32768
  ds_read_b64_tr_b16 v[210:211], v18 offset:34816
  ds_read_b64_tr_b16 v[212:213], v19 offset:32768
  ds_read_b64_tr_b16 v[214:215], v19 offset:34816
  ds_read_b64_tr_b16 v[216:217], v20 offset:32768
  ds_read_b64_tr_b16 v[218:219], v20 offset:34816
  ds_read_b64_tr_b16 v[220:221], v21 offset:32768
  ds_read_b64_tr_b16 v[222:223], v21 offset:34816
  ds_read_b64_tr_b16 v[224:225], v18 offset:36864
  ds_read_b64_tr_b16 v[226:227], v18 offset:38912
  ds_read_b64_tr_b16 v[228:229], v19 offset:36864
  ds_read_b64_tr_b16 v[230:231], v19 offset:38912
  ds_read_b64_tr_b16 v[232:233], v20 offset:36864
  ds_read_b64_tr_b16 v[234:235], v20 offset:38912
  ds_read_b64_tr_b16 v[236:237], v21 offset:36864
  ds_read_b64_tr_b16 v[238:239], v21 offset:38912
  s_waitcnt lgkmcnt(8)
  v_mfma_f32_16x16x32_bf16 v[40:43], v[184:187], v[208:211], 0
  ds_read_b64_tr_b16 v[196:197], v16 offset:11264
  ds_read_b64_tr_b16 v[198:199], v16 offset:16896
  v_mfma_f32_16x16x32_bf16 v[44:47], v[184:187], v[212:215], 0
  ds_read_b64_tr_b16 v[200:201], v16 offset:11296
  ds_read_b64_tr_b16 v[202:203], v16 offset:16928
  v_mfma_f32_16x16x32_bf16 v[48:51], v[184:187], v[216:219], 0
  ds_read_b64_tr_b16 v[204:205], v16 offset:11328
  v_mfma_f32_16x16x32_bf16 v[52:55], v[184:187], v[220:223], 0
  ds_read_b64_tr_b16 v[206:207], v16 offset:16960
  v_mfma_f32_16x16x32_bf16 v[56:59], v[188:191], v[208:211], 0
  ds_read_b64_tr_b16 v[240:241], v18 offset:40960
  v_mfma_f32_16x16x32_bf16 v[60:63], v[188:191], v[212:215], 0
  ds_read_b64_tr_b16 v[242:243], v18 offset:43008
  v_mfma_f32_16x16x32_bf16 v[64:67], v[188:191], v[216:219], 0
  ds_read_b64_tr_b16 v[244:245], v19 offset:40960
  v_mfma_f32_16x16x32_bf16 v[68:71], v[188:191], v[220:223], 0
  ds_read_b64_tr_b16 v[246:247], v19 offset:43008
  v_mfma_f32_16x16x32_bf16 v[72:75], v[192:195], v[208:211], 0
  ds_read_b64_tr_b16 v[248:249], v20 offset:40960
  v_mfma_f32_16x16x32_bf16 v[76:79], v[192:195], v[212:215], 0
  ds_read_b64_tr_b16 v[250:251], v20 offset:43008
  v_mfma_f32_16x16x32_bf16 v[80:83], v[192:195], v[216:219], 0
  ds_read_b64_tr_b16 v[252:253], v21 offset:40960
  v_mfma_f32_16x16x32_bf16 v[84:87], v[192:195], v[220:223], 0
  ds_read_b64_tr_b16 v[254:255], v21 offset:43008
  s_waitcnt lgkmcnt(8)
  s_waitcnt vmcnt(4)
  s_barrier
  v_mfma_f32_16x16x32_bf16 v[40:43], v[196:199], v[224:227], v[40:43]
  ds_read_b64_tr_b16 v[184:185], v16 offset:22528
  ds_read_b64_tr_b16 v[186:187], v16 offset:28160
  v_mfma_f32_16x16x32_bf16 v[44:47], v[196:199], v[228:231], v[44:47]
  ds_read_b64_tr_b16 v[188:189], v16 offset:22560
  ds_read_b64_tr_b16 v[190:191], v16 offset:28192
  v_mfma_f32_16x16x32_bf16 v[48:51], v[196:199], v[232:235], v[48:51]
  ds_read_b64_tr_b16 v[192:193], v16 offset:22592
  v_mfma_f32_16x16x32_bf16 v[52:55], v[196:199], v[236:239], v[52:55]
  ds_read_b64_tr_b16 v[194:195], v16 offset:28224
  v_mfma_f32_16x16x32_bf16 v[56:59], v[200:203], v[224:227], v[56:59]
  ds_read_b64_tr_b16 v[208:209], v18 offset:45056
  v_mfma_f32_16x16x32_bf16 v[60:63], v[200:203], v[228:231], v[60:63]
  ds_read_b64_tr_b16 v[210:211], v18 offset:47104
  v_mfma_f32_16x16x32_bf16 v[64:67], v[200:203], v[232:235], v[64:67]
  ds_read_b64_tr_b16 v[212:213], v19 offset:45056
  v_mfma_f32_16x16x32_bf16 v[68:71], v[200:203], v[236:239], v[68:71]
  ds_read_b64_tr_b16 v[214:215], v19 offset:47104
  v_mfma_f32_16x16x32_bf16 v[72:75], v[204:207], v[224:227], v[72:75]
  ds_read_b64_tr_b16 v[216:217], v20 offset:45056
  v_mfma_f32_16x16x32_bf16 v[76:79], v[204:207], v[228:231], v[76:79]
  ds_read_b64_tr_b16 v[218:219], v20 offset:47104
  v_mfma_f32_16x16x32_bf16 v[80:83], v[204:207], v[232:235], v[80:83]
  ds_read_b64_tr_b16 v[220:221], v21 offset:45056
  v_mfma_f32_16x16x32_bf16 v[84:87], v[204:207], v[236:239], v[84:87]
  ds_read_b64_tr_b16 v[222:223], v21 offset:47104
  s_waitcnt lgkmcnt(8)
  v_mfma_f32_16x16x32_bf16 v[40:43], v[184:187], v[240:243], v[40:43]
  ds_read_b64_tr_b16 v[196:197], v16 offset:33792
  ds_read_b64_tr_b16 v[198:199], v16 offset:39424
  v_mfma_f32_16x16x32_bf16 v[44:47], v[184:187], v[244:247], v[44:47]
  ds_read_b64_tr_b16 v[200:201], v16 offset:33824
  ds_read_b64_tr_b16 v[202:203], v16 offset:39456
  v_mfma_f32_16x16x32_bf16 v[48:51], v[184:187], v[248:251], v[48:51]
  ds_read_b64_tr_b16 v[204:205], v16 offset:33856
  v_mfma_f32_16x16x32_bf16 v[52:55], v[184:187], v[252:255], v[52:55]
  ds_read_b64_tr_b16 v[206:207], v16 offset:39488
  v_mfma_f32_16x16x32_bf16 v[56:59], v[188:191], v[240:243], v[56:59]
  ds_read_b64_tr_b16 v[224:225], v18 offset:49152
  v_mfma_f32_16x16x32_bf16 v[60:63], v[188:191], v[244:247], v[60:63]
  ds_read_b64_tr_b16 v[226:227], v18 offset:51200
  v_mfma_f32_16x16x32_bf16 v[64:67], v[188:191], v[248:251], v[64:67]
  ds_read_b64_tr_b16 v[228:229], v19 offset:49152
  v_mfma_f32_16x16x32_bf16 v[68:71], v[188:191], v[252:255], v[68:71]
  ds_read_b64_tr_b16 v[230:231], v19 offset:51200
  v_mfma_f32_16x16x32_bf16 v[72:75], v[192:195], v[240:243], v[72:75]
  ds_read_b64_tr_b16 v[232:233], v20 offset:49152
  v_mfma_f32_16x16x32_bf16 v[76:79], v[192:195], v[244:247], v[76:79]
  ds_read_b64_tr_b16 v[234:235], v20 offset:51200
  v_mfma_f32_16x16x32_bf16 v[80:83], v[192:195], v[248:251], v[80:83]
  ds_read_b64_tr_b16 v[236:237], v21 offset:49152
  v_mfma_f32_16x16x32_bf16 v[84:87], v[192:195], v[252:255], v[84:87]
  ds_read_b64_tr_b16 v[238:239], v21 offset:51200
  s_waitcnt lgkmcnt(8)
  s_waitcnt vmcnt(2)
  s_barrier
  v_mfma_f32_16x16x32_bf16 v[40:43], v[196:199], v[208:211], v[40:43]
  ds_read_b64_tr_b16 v[184:185], v17 offset:0
  ds_read_b64_tr_b16 v[186:187], v17 offset:5632
  v_mfma_f32_16x16x32_bf16 v[44:47], v[196:199], v[212:215], v[44:47]
  ds_read_b64_tr_b16 v[188:189], v17 offset:32
  ds_read_b64_tr_b16 v[190:191], v17 offset:5664
  v_mfma_f32_16x16x32_bf16 v[48:51], v[196:199], v[216:219], v[48:51]
  ds_read_b64_tr_b16 v[192:193], v17 offset:64
  v_mfma_f32_16x16x32_bf16 v[52:55], v[196:199], v[220:223], v[52:55]
  ds_read_b64_tr_b16 v[194:195], v17 offset:5696
  v_mfma_f32_16x16x32_bf16 v[56:59], v[200:203], v[208:211], v[56:59]
  ds_read_b64_tr_b16 v[240:241], v18 offset:53248
  v_mfma_f32_16x16x32_bf16 v[60:63], v[200:203], v[212:215], v[60:63]
  ds_read_b64_tr_b16 v[242:243], v18 offset:55296
  v_mfma_f32_16x16x32_bf16 v[64:67], v[200:203], v[216:219], v[64:67]
  ds_read_b64_tr_b16 v[244:245], v19 offset:53248
  v_mfma_f32_16x16x32_bf16 v[68:71], v[200:203], v[220:223], v[68:71]
  ds_read_b64_tr_b16 v[246:247], v19 offset:55296
  v_mfma_f32_16x16x32_bf16 v[72:75], v[204:207], v[208:211], v[72:75]
  ds_read_b64_tr_b16 v[248:249], v20 offset:53248
  v_mfma_f32_16x16x32_bf16 v[76:79], v[204:207], v[212:215], v[76:79]
  ds_read_b64_tr_b16 v[250:251], v20 offset:55296
  v_mfma_f32_16x16x32_bf16 v[80:83], v[204:207], v[216:219], v[80:83]
  ds_read_b64_tr_b16 v[252:253], v21 offset:53248
  v_mfma_f32_16x16x32_bf16 v[84:87], v[204:207], v[220:223], v[84:87]
  ds_read_b64_tr_b16 v[254:255], v21 offset:55296
  s_waitcnt lgkmcnt(8)
  v_mfma_f32_16x16x32_bf16 v[40:43], v[184:187], v[224:227], v[40:43]
  ds_read_b64_tr_b16 v[196:197], v17 offset:11264
  ds_read_b64_tr_b16 v[198:199], v17 offset:16896
  v_mfma_f32_16x16x32_bf16 v[44:47], v[184:187], v[228:231], v[44:47]
  ds_read_b64_tr_b16 v[200:201], v17 offset:11296
  ds_read_b64_tr_b16 v[202:203], v17 offset:16928
  v_mfma_f32_16x16x32_bf16 v[48:51], v[184:187], v[232:235], v[48:51]
  ds_read_b64_tr_b16 v[204:205], v17 offset:11328
  v_mfma_f32_16x16x32_bf16 v[52:55], v[184:187], v[236:239], v[52:55]
  ds_read_b64_tr_b16 v[206:207], v17 offset:16960
  v_mfma_f32_16x16x32_bf16 v[56:59], v[188:191], v[224:227], v[56:59]
  ds_read_b64_tr_b16 v[208:209], v18 offset:57344
  v_mfma_f32_16x16x32_bf16 v[60:63], v[188:191], v[228:231], v[60:63]
  ds_read_b64_tr_b16 v[210:211], v18 offset:59392
  v_mfma_f32_16x16x32_bf16 v[64:67], v[188:191], v[232:235], v[64:67]
  ds_read_b64_tr_b16 v[212:213], v19 offset:57344
  v_mfma_f32_16x16x32_bf16 v[68:71], v[188:191], v[236:239], v[68:71]
  ds_read_b64_tr_b16 v[214:215], v19 offset:59392
  v_mfma_f32_16x16x32_bf16 v[72:75], v[192:195], v[224:227], v[72:75]
  ds_read_b64_tr_b16 v[216:217], v20 offset:57344
  v_mfma_f32_16x16x32_bf16 v[76:79], v[192:195], v[228:231], v[76:79]
  ds_read_b64_tr_b16 v[218:219], v20 offset:59392
  v_mfma_f32_16x16x32_bf16 v[80:83], v[192:195], v[232:235], v[80:83]
  ds_read_b64_tr_b16 v[220:221], v21 offset:57344
  v_mfma_f32_16x16x32_bf16 v[84:87], v[192:195], v[236:239], v[84:87]
  ds_read_b64_tr_b16 v[222:223], v21 offset:59392
  s_waitcnt lgkmcnt(8)
  s_waitcnt vmcnt(0)
  s_barrier
  ds_read_b64_tr_b16 v[14:15], v12 offset:2048
  ds_read_b64_tr_b16 v[12:13], v12 offset:0
  v_mfma_f32_16x16x32_bf16 v[40:43], v[196:199], v[240:243], v[40:43]
  ds_read_b64_tr_b16 v[184:185], v17 offset:22528
  ds_read_b64_tr_b16 v[186:187], v17 offset:28160
  v_mfma_f32_16x16x32_bf16 v[44:47], v[196:199], v[244:247], v[44:47]
  ds_read_b64_tr_b16 v[188:189], v17 offset:22560
  ds_read_b64_tr_b16 v[190:191], v17 offset:28192
  v_mfma_f32_16x16x32_bf16 v[48:51], v[196:199], v[248:251], v[48:51]
  ds_read_b64_tr_b16 v[192:193], v17 offset:22592
  v_mfma_f32_16x16x32_bf16 v[52:55], v[196:199], v[252:255], v[52:55]
  ds_read_b64_tr_b16 v[194:195], v17 offset:28224
  v_mfma_f32_16x16x32_bf16 v[56:59], v[200:203], v[240:243], v[56:59]
  ds_read_b64_tr_b16 v[224:225], v18 offset:61440
  v_mfma_f32_16x16x32_bf16 v[60:63], v[200:203], v[244:247], v[60:63]
  ds_read_b64_tr_b16 v[226:227], v18 offset:63488
  v_mfma_f32_16x16x32_bf16 v[64:67], v[200:203], v[248:251], v[64:67]
  ds_read_b64_tr_b16 v[228:229], v19 offset:61440
  v_mfma_f32_16x16x32_bf16 v[68:71], v[200:203], v[252:255], v[68:71]
  ds_read_b64_tr_b16 v[230:231], v19 offset:63488
  v_mfma_f32_16x16x32_bf16 v[72:75], v[204:207], v[240:243], v[72:75]
  ds_read_b64_tr_b16 v[232:233], v20 offset:61440
  v_mfma_f32_16x16x32_bf16 v[76:79], v[204:207], v[244:247], v[76:79]
  ds_read_b64_tr_b16 v[234:235], v20 offset:63488
  v_mfma_f32_16x16x32_bf16 v[80:83], v[204:207], v[248:251], v[80:83]
  ds_read_b64_tr_b16 v[236:237], v21 offset:61440
  v_mfma_f32_16x16x32_bf16 v[84:87], v[204:207], v[252:255], v[84:87]
  ds_read_b64_tr_b16 v[238:239], v21 offset:63488
  s_waitcnt lgkmcnt(8)
  v_mfma_f32_16x16x32_bf16 v[40:43], v[184:187], v[208:211], v[40:43]
  ds_read_b64_tr_b16 v[196:197], v17 offset:33792
  ds_read_b64_tr_b16 v[198:199], v17 offset:39424
  v_mfma_f32_16x16x32_bf16 v[44:47], v[184:187], v[212:215], v[44:47]
  ds_read_b64_tr_b16 v[200:201], v17 offset:33824
  ds_read_b64_tr_b16 v[202:203], v17 offset:39456
  v_mfma_f32_16x16x32_bf16 v[48:51], v[184:187], v[216:219], v[48:51]
  ds_read_b64_tr_b16 v[204:205], v17 offset:33856
  v_mfma_f32_16x16x32_bf16 v[52:55], v[184:187], v[220:223], v[52:55]
  ds_read_b64_tr_b16 v[206:207], v17 offset:39488
  v_mfma_f32_16x16x32_bf16 v[56:59], v[188:191], v[208:211], v[56:59]
  ds_read_b64_tr_b16 v[240:241], v18 offset:0
  v_mfma_f32_16x16x32_bf16 v[60:63], v[188:191], v[212:215], v[60:63]
  ds_read_b64_tr_b16 v[242:243], v18 offset:2048
  v_mfma_f32_16x16x32_bf16 v[64:67], v[188:191], v[216:219], v[64:67]
  ds_read_b64_tr_b16 v[244:245], v19 offset:0
  v_mfma_f32_16x16x32_bf16 v[68:71], v[188:191], v[220:223], v[68:71]
  ds_read_b64_tr_b16 v[246:247], v19 offset:2048
  v_mfma_f32_16x16x32_bf16 v[72:75], v[192:195], v[208:211], v[72:75]
  ds_read_b64_tr_b16 v[248:249], v20 offset:0
  v_mfma_f32_16x16x32_bf16 v[76:79], v[192:195], v[212:215], v[76:79]
  ds_read_b64_tr_b16 v[250:251], v20 offset:2048
  v_mfma_f32_16x16x32_bf16 v[80:83], v[192:195], v[216:219], v[80:83]
  ds_read_b64_tr_b16 v[252:253], v21 offset:0
  v_mfma_f32_16x16x32_bf16 v[84:87], v[192:195], v[220:223], v[84:87]
  ds_read_b64_tr_b16 v[254:255], v21 offset:2048
  s_waitcnt lgkmcnt(8)
  s_mov_b64 exec, 1
  ds_add_u32 v1, v4 offset:12
  s_mov_b64 exec, -1
  v_mfma_f32_16x16x32_bf16 v[40:43], v[196:199], v[224:227], v[40:43]
  ds_read_b64_tr_b16 v[208:209], v18 offset:4096
  ds_read_b64_tr_b16 v[210:211], v18 offset:6144
  v_mfma_f32_16x16x32_bf16 v[44:47], v[196:199], v[228:231], v[44:47]
  ds_read_b64_tr_b16 v[212:213], v19 offset:4096
  ds_read_b64_tr_b16 v[214:215], v19 offset:6144
  v_mfma_f32_16x16x32_bf16 v[48:51], v[196:199], v[232:235], v[48:51]
  ds_read_b64_tr_b16 v[216:217], v20 offset:4096
  v_mfma_f32_16x16x32_bf16 v[52:55], v[196:199], v[236:239], v[52:55]
  ds_read_b64_tr_b16 v[218:219], v20 offset:6144
  v_mfma_f32_16x16x32_bf16 v[56:59], v[200:203], v[224:227], v[56:59]
  ds_read_b64_tr_b16 v[220:221], v21 offset:4096
  v_mfma_f32_16x16x32_bf16 v[60:63], v[200:203], v[228:231], v[60:63]
  ds_read_b64_tr_b16 v[222:223], v21 offset:6144
  v_mfma_f32_16x16x32_bf16 v[64:67], v[200:203], v[232:235], v[64:67]
  v_mfma_f32_16x16x32_bf16 v[68:71], v[200:203], v[236:239], v[68:71]
  v_mfma_f32_16x16x32_bf16 v[72:75], v[204:207], v[224:227], v[72:75]
  v_mfma_f32_16x16x32_bf16 v[76:79], v[204:207], v[228:231], v[76:79]
  v_mfma_f32_16x16x32_bf16 v[80:83], v[204:207], v[232:235], v[80:83]
  v_mfma_f32_16x16x32_bf16 v[84:87], v[204:207], v[236:239], v[84:87]
  s_waitcnt lgkmcnt(8)
  v_mfma_f32_16x16x32_bf16 v[40:43], v[88:91], v[240:243], v[40:43]
  ds_read_b64_tr_b16 v[224:225], v18 offset:8192
  ds_read_b64_tr_b16 v[226:227], v18 offset:10240
  v_mfma_f32_16x16x32_bf16 v[44:47], v[88:91], v[244:247], v[44:47]
  ds_read_b64_tr_b16 v[228:229], v19 offset:8192
  ds_read_b64_tr_b16 v[230:231], v19 offset:10240
  v_mfma_f32_16x16x32_bf16 v[48:51], v[88:91], v[248:251], v[48:51]
  ds_read_b64_tr_b16 v[232:233], v20 offset:8192
  v_mfma_f32_16x16x32_bf16 v[52:55], v[88:91], v[252:255], v[52:55]
  ds_read_b64_tr_b16 v[234:235], v20 offset:10240
  v_mfma_f32_16x16x32_bf16 v[56:59], v[92:95], v[240:243], v[56:59]
  ds_read_b64_tr_b16 v[236:237], v21 offset:8192
  v_mfma_f32_16x16x32_bf16 v[60:63], v[92:95], v[244:247], v[60:63]
  ds_read_b64_tr_b16 v[238:239], v21 offset:10240
  v_mfma_f32_16x16x32_bf16 v[64:67], v[92:95], v[248:251], v[64:67]
  v_mfma_f32_16x16x32_bf16 v[68:71], v[92:95], v[252:255], v[68:71]
  v_mfma_f32_16x16x32_bf16 v[72:75], v[96:99], v[240:243], v[72:75]
  v_mfma_f32_16x16x32_bf16 v[76:79], v[96:99], v[244:247], v[76:79]
  v_mfma_f32_16x16x32_bf16 v[80:83], v[96:99], v[248:251], v[80:83]
  v_mfma_f32_16x16x32_bf16 v[84:87], v[96:99], v[252:255], v[84:87]
  s_waitcnt lgkmcnt(8)
  v_mfma_f32_16x16x32_bf16 v[40:43], v[100:103], v[208:211], v[40:43]
  ds_read_b64_tr_b16 v[240:241], v18 offset:12288
  ds_read_b64_tr_b16 v[242:243], v18 offset:14336
  v_mfma_f32_16x16x32_bf16 v[44:47], v[100:103], v[212:215], v[44:47]
  ds_read_b64_tr_b16 v[244:245], v19 offset:12288
  ds_read_b64_tr_b16 v[246:247], v19 offset:14336
  v_mfma_f32_16x16x32_bf16 v[48:51], v[100:103], v[216:219], v[48:51]
  ds_read_b64_tr_b16 v[248:249], v20 offset:12288
  v_mfma_f32_16x16x32_bf16 v[52:55], v[100:103], v[220:223], v[52:55]
  ds_read_b64_tr_b16 v[250:251], v20 offset:14336
  v_mfma_f32_16x16x32_bf16 v[56:59], v[104:107], v[208:211], v[56:59]
  ds_read_b64_tr_b16 v[252:253], v21 offset:12288
  v_mfma_f32_16x16x32_bf16 v[60:63], v[104:107], v[212:215], v[60:63]
  ds_read_b64_tr_b16 v[254:255], v21 offset:14336
  v_mfma_f32_16x16x32_bf16 v[64:67], v[104:107], v[216:219], v[64:67]
  v_mfma_f32_16x16x32_bf16 v[68:71], v[104:107], v[220:223], v[68:71]
  v_mfma_f32_16x16x32_bf16 v[72:75], v[108:111], v[208:211], v[72:75]
  v_mfma_f32_16x16x32_bf16 v[76:79], v[108:111], v[212:215], v[76:79]
  v_mfma_f32_16x16x32_bf16 v[80:83], v[108:111], v[216:219], v[80:83]
  v_mfma_f32_16x16x32_bf16 v[84:87], v[108:111], v[220:223], v[84:87]
  s_waitcnt lgkmcnt(8)
  v_mfma_f32_16x16x32_bf16 v[40:43], v[112:115], v[224:227], v[40:43]
  ds_read_b64_tr_b16 v[208:209], v18 offset:16384
  ds_read_b64_tr_b16 v[210:211], v18 offset:18432
  v_mfma_f32_16x16x32_bf16 v[44:47], v[112:115], v[228:231], v[44:47]
  ds_read_b64_tr_b16 v[212:213], v19 offset:16384
  ds_read_b64_tr_b16 v[214:215], v19 offset:18432
  v_mfma_f32_16x16x32_bf16 v[48:51], v[112:115], v[232:235], v[48:51]
  ds_read_b64_tr_b16 v[216:217], v20 offset:16384
  v_mfma_f32_16x16x32_bf16 v[52:55], v[112:115], v[236:239], v[52:55]
  ds_read_b64_tr_b16 v[218:219], v20 offset:18432
  v_mfma_f32_16x16x32_bf16 v[56:59], v[116:119], v[224:227], v[56:59]
  ds_read_b64_tr_b16 v[220:221], v21 offset:16384
  v_mfma_f32_16x16x32_bf16 v[60:63], v[116:119], v[228:231], v[60:63]
  ds_read_b64_tr_b16 v[222:223], v21 offset:18432
  v_mfma_f32_16x16x32_bf16 v[64:67], v[116:119], v[232:235], v[64:67]
  v_mfma_f32_16x16x32_bf16 v[68:71], v[116:119], v[236:239], v[68:71]
  v_mfma_f32_16x16x32_bf16 v[72:75], v[120:123], v[224:227], v[72:75]
  v_mfma_f32_16x16x32_bf16 v[76:79], v[120:123], v[228:231], v[76:79]
  v_mfma_f32_16x16x32_bf16 v[80:83], v[120:123], v[232:235], v[80:83]
  v_mfma_f32_16x16x32_bf16 v[84:87], v[120:123], v[236:239], v[84:87]
  s_waitcnt lgkmcnt(8)
  v_mfma_f32_16x16x32_bf16 v[40:43], v[124:127], v[240:243], v[40:43]
  ds_read_b64_tr_b16 v[224:225], v18 offset:20480
  ds_read_b64_tr_b16 v[226:227], v18 offset:22528
  v_mfma_f32_16x16x32_bf16 v[44:47], v[124:127], v[244:247], v[44:47]
  ds_read_b64_tr_b16 v[228:229], v19 offset:20480
  ds_read_b64_tr_b16 v[230:231], v19 offset:22528
  v_mfma_f32_16x16x32_bf16 v[48:51], v[124:127], v[248:251], v[48:51]
  ds_read_b64_tr_b16 v[232:233], v20 offset:20480
  v_mfma_f32_16x16x32_bf16 v[52:55], v[124:127], v[252:255], v[52:55]
  ds_read_b64_tr_b16 v[234:235], v20 offset:22528
  v_mfma_f32_16x16x32_bf16 v[56:59], v[128:131], v[240:243], v[56:59]
  ds_read_b64_tr_b16 v[236:237], v21 offset:20480
  v_mfma_f32_16x16x32_bf16 v[60:63], v[128:131], v[244:247], v[60:63]
  ds_read_b64_tr_b16 v[238:239], v21 offset:22528
  v_mfma_f32_16x16x32_bf16 v[64:67], v[128:131], v[248:251], v[64:67]
  v_mfma_f32_16x16x32_bf16 v[68:71], v[128:131], v[252:255], v[68:71]
  v_mfma_f32_16x16x32_bf16 v[72:75], v[132:135], v[240:243], v[72:75]
  v_mfma_f32_16x16x32_bf16 v[76:79], v[132:135], v[244:247], v[76:79]
  v_mfma_f32_16x16x32_bf16 v[80:83], v[132:135], v[248:251], v[80:83]
  v_mfma_f32_16x16x32_bf16 v[84:87], v[132:135], v[252:255], v[84:87]
  s_waitcnt lgkmcnt(8)
  s_mov_b64 exec, 1
  ds_add_u32 v1, v4 offset:24
  s_mov_b64 exec, -1
  v_mfma_f32_16x16x32_bf16 v[40:43], v[136:139], v[208:211], v[40:43]
  ds_read_b64_tr_b16 v[240:241], v18 offset:24576
  ds_read_b64_tr_b16 v[242:243], v18 offset:26624
  v_mfma_f32_16x16x32_bf16 v[44:47], v[136:139], v[212:215], v[44:47]
  ds_read_b64_tr_b16 v[244:245], v19 offset:24576
  ds_read_b64_tr_b16 v[246:247], v19 offset:26624
  v_mfma_f32_16x16x32_bf16 v[48:51], v[136:139], v[216:219], v[48:51]
  ds_read_b64_tr_b16 v[248:249], v20 offset:24576
  v_mfma_f32_16x16x32_bf16 v[52:55], v[136:139], v[220:223], v[52:55]
  ds_read_b64_tr_b16 v[250:251], v20 offset:26624
  v_mfma_f32_16x16x32_bf16 v[56:59], v[140:143], v[208:211], v[56:59]
  ds_read_b64_tr_b16 v[252:253], v21 offset:24576
  v_mfma_f32_16x16x32_bf16 v[60:63], v[140:143], v[212:215], v[60:63]
  ds_read_b64_tr_b16 v[254:255], v21 offset:26624
  v_mfma_f32_16x16x32_bf16 v[64:67], v[140:143], v[216:219], v[64:67]
  v_mfma_f32_16x16x32_bf16 v[68:71], v[140:143], v[220:223], v[68:71]
  v_mfma_f32_16x16x32_bf16 v[72:75], v[144:147], v[208:211], v[72:75]
  v_mfma_f32_16x16x32_bf16 v[76:79], v[144:147], v[212:215], v[76:79]
  v_mfma_f32_16x16x32_bf16 v[80:83], v[144:147], v[216:219], v[80:83]
  v_mfma_f32_16x16x32_bf16 v[84:87], v[144:147], v[220:223], v[84:87]
  s_waitcnt lgkmcnt(8)
  v_mfma_f32_16x16x32_bf16 v[40:43], v[148:151], v[224:227], v[40:43]
  ds_read_b64_tr_b16 v[208:209], v18 offset:28672
  ds_read_b64_tr_b16 v[210:211], v18 offset:30720
  v_mfma_f32_16x16x32_bf16 v[44:47], v[148:151], v[228:231], v[44:47]
  ds_read_b64_tr_b16 v[212:213], v19 offset:28672
  ds_read_b64_tr_b16 v[214:215], v19 offset:30720
  v_mfma_f32_16x16x32_bf16 v[48:51], v[148:151], v[232:235], v[48:51]
  ds_read_b64_tr_b16 v[216:217], v20 offset:28672
  v_mfma_f32_16x16x32_bf16 v[52:55], v[148:151], v[236:239], v[52:55]
  ds_read_b64_tr_b16 v[218:219], v20 offset:30720
  v_mfma_f32_16x16x32_bf16 v[56:59], v[152:155], v[224:227], v[56:59]
  ds_read_b64_tr_b16 v[220:221], v21 offset:28672
  v_mfma_f32_16x16x32_bf16 v[60:63], v[152:155], v[228:231], v[60:63]
  ds_read_b64_tr_b16 v[222:223], v21 offset:30720
  v_mfma_f32_16x16x32_bf16 v[64:67], v[152:155], v[232:235], v[64:67]
  v_mfma_f32_16x16x32_bf16 v[68:71], v[152:155], v[236:239], v[68:71]
  v_mfma_f32_16x16x32_bf16 v[72:75], v[156:159], v[224:227], v[72:75]
  v_mfma_f32_16x16x32_bf16 v[76:79], v[156:159], v[228:231], v[76:79]
  v_mfma_f32_16x16x32_bf16 v[80:83], v[156:159], v[232:235], v[80:83]
  v_mfma_f32_16x16x32_bf16 v[84:87], v[156:159], v[236:239], v[84:87]
  s_waitcnt lgkmcnt(8)
  v_mfma_f32_16x16x32_bf16 v[40:43], v[160:163], v[240:243], v[40:43]
  v_mfma_f32_16x16x32_bf16 v[44:47], v[160:163], v[244:247], v[44:47]
  v_mfma_f32_16x16x32_bf16 v[48:51], v[160:163], v[248:251], v[48:51]
  v_mfma_f32_16x16x32_bf16 v[52:55], v[160:163], v[252:255], v[52:55]
  v_mfma_f32_16x16x32_bf16 v[56:59], v[164:167], v[240:243], v[56:59]
  v_mfma_f32_16x16x32_bf16 v[60:63], v[164:167], v[244:247], v[60:63]
  v_mfma_f32_16x16x32_bf16 v[64:67], v[164:167], v[248:251], v[64:67]
  v_mfma_f32_16x16x32_bf16 v[68:71], v[164:167], v[252:255], v[68:71]
  v_mfma_f32_16x16x32_bf16 v[72:75], v[168:171], v[240:243], v[72:75]
  v_mfma_f32_16x16x32_bf16 v[76:79], v[168:171], v[244:247], v[76:79]
  v_mfma_f32_16x16x32_bf16 v[80:83], v[168:171], v[248:251], v[80:83]
  v_mfma_f32_16x16x32_bf16 v[84:87], v[168:171], v[252:255], v[84:87]
  s_waitcnt lgkmcnt(0)
  v_mfma_f32_16x16x32_bf16 v[40:43], v[172:175], v[208:211], v[40:43]
  v_mfma_f32_16x16x32_bf16 v[44:47], v[172:175], v[212:215], v[44:47]
  v_mfma_f32_16x16x32_bf16 v[48:51], v[172:175], v[216:219], v[48:51]
  v_mfma_f32_16x16x32_bf16 v[52:55], v[172:175], v[220:223], v[52:55]
  s_mov_b32 s3, 0
L_sequential_preLN__ssm_conv_h3__dense_activation_silu__prompt_kernel_32:
  ds_read_b32 v5, v1 offset:0
  s_add_u32 s3, s3, 1
  s_waitcnt lgkmcnt(0)
  v_readfirstlane_b32 s50, v5
  s_cmp_ge_u32 s50, 4
  s_cbranch_scc1 L_sequential_preLN__ssm_conv_h3__dense_activation_silu__prompt_kernel_33
  s_cmp_lt_u32 s3, 2097152
  s_cbranch_scc1 L_sequential_preLN__ssm_conv_h3__dense_activation_silu__prompt_kernel_32
L_sequential_preLN__ssm_conv_h3__dense_activation_silu__prompt_kernel_33:
  ds_read_b128 v[88:91], v24
  ds_read_b128 v[92:95], v25
  ds_read_b128 v[96:99], v26
  ds_read_b128 v[100:103], v27
  v_mfma_f32_16x16x32_bf16 v[56:59], v[176:179], v[208:211], v[56:59]
  v_mfma_f32_16x16x32_bf16 v[60:63], v[176:179], v[212:215], v[60:63]
  v_mfma_f32_16x16x32_bf16 v[64:67], v[176:179], v[216:219], v[64:67]
  v_mfma_f32_16x16x32_bf16 v[68:71], v[176:179], v[220:223], v[68:71]
  v_mfma_f32_16x16x32_bf16 v[72:75], v[180:183], v[208:211], v[72:75]
  v_mfma_f32_16x16x32_bf16 v[76:79], v[180:183], v[212:215], v[76:79]
  v_mfma_f32_16x16x32_bf16 v[80:83], v[180:183], v[216:219], v[80:83]
  v_mfma_f32_16x16x32_bf16 v[84:87], v[180:183], v[220:223], v[84:87]
  v_mov_b32 v104, 0xbfb8aa3b
  v_mov_b32 v105, 0xbfb8aa3b
  s_waitcnt lgkmcnt(0)
  v_pk_mul_f32 v[40:41], v[40:41], v[88:89]
  v_pk_mul_f32 v[42:43], v[42:43], v[88:89]
  v_pk_mul_f32 v[44:45], v[44:45], v[92:93]
  v_pk_mul_f32 v[46:47], v[46:47], v[92:93]
  v_pk_fma_f32 v[40:41], v[28:29], v[90:91], v[40:41]
  v_pk_fma_f32 v[42:43], v[30:31], v[90:91], v[42:43]
  v_pk_fma_f32 v[44:45], v[28:29], v[94:95], v[44:45]
  v_pk_fma_f32 v[46:47], v[30:31], v[94:95], v[46:47]
  v_exp_f32 v112, v40
  v_exp_f32 v113, v41
  v_exp_f32 v114, v42
  v_exp_f32 v115, v43
  v_exp_f32 v116, v44
  v_exp_f32 v117, v45
  v_exp_f32 v118, v46
  v_exp_f32 v119, v47
  v_pk_fma_f32 v[112:113], v[112:113], v[104:105], v[104:105]
  v_pk_fma_f32 v[114:115], v[114:115], v[104:105], v[104:105]
  v_pk_fma_f32 v[116:117], v[116:117], v[104:105], v[104:105]
  v_pk_fma_f32 v[118:119], v[118:119], v[104:105], v[104:105]
  v_rcp_f32 v112, v112
  v_rcp_f32 v113, v113
  v_rcp_f32 v114, v114
  v_rcp_f32 v115, v115
  v_rcp_f32 v116, v116
  v_rcp_f32 v117, v117
  v_rcp_f32 v118, v118
  v_rcp_f32 v119, v119
  v_pk_mul_f32 v[40:41], v[40:41], v[112:113]
  v_pk_mul_f32 v[42:43], v[42:43], v[114:115]
  v_pk_mul_f32 v[44:45], v[44:45], v[116:117]
  v_pk_mul_f32 v[46:47], v[46:47], v[118:119]
  v_cvt_pk_bf16_f32 v224, v40, v41
  v_cvt_pk_bf16_f32 v226, v44, v45
  v_cvt_pk_bf16_f32 v225, v42, v43
  v_cvt_pk_bf16_f32 v227, v46, v47
  v_permlane16_swap_b32 v224, v226
  s_nop 0
  v_permlane16_swap_b32 v225, v227
  buffer_store_dwordx4 v[224:227], v22, s[24:27], s58 offen offset:0 sc1
  v_pk_mul_f32 v[48:49], v[48:49], v[96:97]
  v_pk_mul_f32 v[50:51], v[50:51], v[96:97]
  v_pk_mul_f32 v[52:53], v[52:53], v[100:101]
  v_pk_mul_f32 v[54:55], v[54:55], v[100:101]
  v_pk_fma_f32 v[48:49], v[28:29], v[98:99], v[48:49]
  v_pk_fma_f32 v[50:51], v[30:31], v[98:99], v[50:51]
  v_pk_fma_f32 v[52:53], v[28:29], v[102:103], v[52:53]
  v_pk_fma_f32 v[54:55], v[30:31], v[102:103], v[54:55]
  v_exp_f32 v112, v48
  v_exp_f32 v113, v49
  v_exp_f32 v114, v50
  v_exp_f32 v115, v51
  v_exp_f32 v116, v52
  v_exp_f32 v117, v53
  v_exp_f32 v118, v54
  v_exp_f32 v119, v55
  v_pk_fma_f32 v[112:113], v[112:113], v[104:105], v[104:105]
  v_pk_fma_f32 v[114:115], v[114:115], v[104:105], v[104:105]
  v_pk_fma_f32 v[116:117], v[116:117], v[104:105], v[104:105]
  v_pk_fma_f32 v[118:119], v[118:119], v[104:105], v[104:105]
  v_rcp_f32 v112, v112
  v_rcp_f32 v113, v113
  v_rcp_f32 v114, v114
  v_rcp_f32 v115, v115
  v_rcp_f32 v116, v116
  v_rcp_f32 v117, v117
  v_rcp_f32 v118, v118
  v_rcp_f32 v119, v119
  v_pk_mul_f32 v[48:49], v[48:49], v[112:113]
  v_pk_mul_f32 v[50:51], v[50:51], v[114:115]
  v_pk_mul_f32 v[52:53], v[52:53], v[116:117]
  v_pk_mul_f32 v[54:55], v[54:55], v[118:119]
  v_cvt_pk_bf16_f32 v228, v48, v49
  v_cvt_pk_bf16_f32 v230, v52, v53
  v_cvt_pk_bf16_f32 v229, v50, v51
  v_cvt_pk_bf16_f32 v231, v54, v55
  v_permlane16_swap_b32 v228, v230
  s_nop 0
  v_permlane16_swap_b32 v229, v231
  buffer_store_dwordx4 v[228:231], v23, s[24:27], s58 offen offset:0 sc1
  v_pk_mul_f32 v[56:57], v[56:57], v[88:89]
  v_pk_mul_f32 v[58:59], v[58:59], v[88:89]
  v_pk_mul_f32 v[60:61], v[60:61], v[92:93]
  v_pk_mul_f32 v[62:63], v[62:63], v[92:93]
  v_pk_fma_f32 v[56:57], v[32:33], v[90:91], v[56:57]
  v_pk_fma_f32 v[58:59], v[34:35], v[90:91], v[58:59]
  v_pk_fma_f32 v[60:61], v[32:33], v[94:95], v[60:61]
  v_pk_fma_f32 v[62:63], v[34:35], v[94:95], v[62:63]
  v_exp_f32 v112, v56
  v_exp_f32 v113, v57
  v_exp_f32 v114, v58
  v_exp_f32 v115, v59
  v_exp_f32 v116, v60
  v_exp_f32 v117, v61
  v_exp_f32 v118, v62
  v_exp_f32 v119, v63
  v_pk_fma_f32 v[112:113], v[112:113], v[104:105], v[104:105]
  v_pk_fma_f32 v[114:115], v[114:115], v[104:105], v[104:105]
  v_pk_fma_f32 v[116:117], v[116:117], v[104:105], v[104:105]
  v_pk_fma_f32 v[118:119], v[118:119], v[104:105], v[104:105]
  v_rcp_f32 v112, v112
  v_rcp_f32 v113, v113
  v_rcp_f32 v114, v114
  v_rcp_f32 v115, v115
  v_rcp_f32 v116, v116
  v_rcp_f32 v117, v117
  v_rcp_f32 v118, v118
  v_rcp_f32 v119, v119
  v_pk_mul_f32 v[56:57], v[56:57], v[112:113]
  v_pk_mul_f32 v[58:59], v[58:59], v[114:115]
  v_pk_mul_f32 v[60:61], v[60:61], v[116:117]
  v_pk_mul_f32 v[62:63], v[62:63], v[118:119]
  v_cvt_pk_bf16_f32 v232, v56, v57
  v_cvt_pk_bf16_f32 v234, v60, v61
  v_cvt_pk_bf16_f32 v233, v58, v59
  v_cvt_pk_bf16_f32 v235, v62, v63
  v_permlane16_swap_b32 v232, v234
  s_nop 0
  v_permlane16_swap_b32 v233, v235
  buffer_store_dwordx4 v[232:235], v22, s[24:27], s58 offen offset:512 sc1
  v_pk_mul_f32 v[64:65], v[64:65], v[96:97]
  v_pk_mul_f32 v[66:67], v[66:67], v[96:97]
  v_pk_mul_f32 v[68:69], v[68:69], v[100:101]
  v_pk_mul_f32 v[70:71], v[70:71], v[100:101]
  v_pk_fma_f32 v[64:65], v[32:33], v[98:99], v[64:65]
  v_pk_fma_f32 v[66:67], v[34:35], v[98:99], v[66:67]
  v_pk_fma_f32 v[68:69], v[32:33], v[102:103], v[68:69]
  v_pk_fma_f32 v[70:71], v[34:35], v[102:103], v[70:71]
  v_exp_f32 v112, v64
  v_exp_f32 v113, v65
  v_exp_f32 v114, v66
  v_exp_f32 v115, v67
  v_exp_f32 v116, v68
  v_exp_f32 v117, v69
  v_exp_f32 v118, v70
  v_exp_f32 v119, v71
  v_pk_fma_f32 v[112:113], v[112:113], v[104:105], v[104:105]
  v_pk_fma_f32 v[114:115], v[114:115], v[104:105], v[104:105]
  v_pk_fma_f32 v[116:117], v[116:117], v[104:105], v[104:105]
  v_pk_fma_f32 v[118:119], v[118:119], v[104:105], v[104:105]
  v_rcp_f32 v112, v112
  v_rcp_f32 v113, v113
  v_rcp_f32 v114, v114
  v_rcp_f32 v115, v115
  v_rcp_f32 v116, v116
  v_rcp_f32 v117, v117
  v_rcp_f32 v118, v118
  v_rcp_f32 v119, v119
  v_pk_mul_f32 v[64:65], v[64:65], v[112:113]
  v_pk_mul_f32 v[66:67], v[66:67], v[114:115]
  v_pk_mul_f32 v[68:69], v[68:69], v[116:117]
  v_pk_mul_f32 v[70:71], v[70:71], v[118:119]
  v_cvt_pk_bf16_f32 v236, v64, v65
  v_cvt_pk_bf16_f32 v238, v68, v69
  v_cvt_pk_bf16_f32 v237, v66, v67
  v_cvt_pk_bf16_f32 v239, v70, v71
  v_permlane16_swap_b32 v236, v238
  s_nop 0
  v_permlane16_swap_b32 v237, v239
  buffer_store_dwordx4 v[236:239], v23, s[24:27], s58 offen offset:512 sc1
  v_pk_mul_f32 v[72:73], v[72:73], v[88:89]
  v_pk_mul_f32 v[74:75], v[74:75], v[88:89]
  v_pk_mul_f32 v[76:77], v[76:77], v[92:93]
  v_pk_mul_f32 v[78:79], v[78:79], v[92:93]
  v_pk_fma_f32 v[72:73], v[36:37], v[90:91], v[72:73]
  v_pk_fma_f32 v[74:75], v[38:39], v[90:91], v[74:75]
  v_pk_fma_f32 v[76:77], v[36:37], v[94:95], v[76:77]
  v_pk_fma_f32 v[78:79], v[38:39], v[94:95], v[78:79]
  v_exp_f32 v112, v72
  v_exp_f32 v113, v73
  v_exp_f32 v114, v74
  v_exp_f32 v115, v75
  v_exp_f32 v116, v76
  v_exp_f32 v117, v77
  v_exp_f32 v118, v78
  v_exp_f32 v119, v79
  v_pk_fma_f32 v[112:113], v[112:113], v[104:105], v[104:105]
  v_pk_fma_f32 v[114:115], v[114:115], v[104:105], v[104:105]
  v_pk_fma_f32 v[116:117], v[116:117], v[104:105], v[104:105]
  v_pk_fma_f32 v[118:119], v[118:119], v[104:105], v[104:105]
  v_rcp_f32 v112, v112
  v_rcp_f32 v113, v113
  v_rcp_f32 v114, v114
  v_rcp_f32 v115, v115
  v_rcp_f32 v116, v116
  v_rcp_f32 v117, v117
  v_rcp_f32 v118, v118
  v_rcp_f32 v119, v119
  v_pk_mul_f32 v[72:73], v[72:73], v[112:113]
  v_pk_mul_f32 v[74:75], v[74:75], v[114:115]
  v_pk_mul_f32 v[76:77], v[76:77], v[116:117]
  v_pk_mul_f32 v[78:79], v[78:79], v[118:119]
  v_cvt_pk_bf16_f32 v240, v72, v73
  v_cvt_pk_bf16_f32 v242, v76, v77
  v_cvt_pk_bf16_f32 v241, v74, v75
  v_cvt_pk_bf16_f32 v243, v78, v79
  v_permlane16_swap_b32 v240, v242
  s_nop 0
  v_permlane16_swap_b32 v241, v243
  buffer_store_dwordx4 v[240:243], v22, s[24:27], s60 offen offset:1024 sc1
  v_pk_mul_f32 v[80:81], v[80:81], v[96:97]
  v_pk_mul_f32 v[82:83], v[82:83], v[96:97]
  v_pk_mul_f32 v[84:85], v[84:85], v[100:101]
  v_pk_mul_f32 v[86:87], v[86:87], v[100:101]
  v_pk_fma_f32 v[80:81], v[36:37], v[98:99], v[80:81]
  v_pk_fma_f32 v[82:83], v[38:39], v[98:99], v[82:83]
  v_pk_fma_f32 v[84:85], v[36:37], v[102:103], v[84:85]
  v_pk_fma_f32 v[86:87], v[38:39], v[102:103], v[86:87]
  v_exp_f32 v112, v80
  v_exp_f32 v113, v81
  v_exp_f32 v114, v82
  v_exp_f32 v115, v83
  v_exp_f32 v116, v84
  v_exp_f32 v117, v85
  v_exp_f32 v118, v86
  v_exp_f32 v119, v87
  v_pk_fma_f32 v[112:113], v[112:113], v[104:105], v[104:105]
  v_pk_fma_f32 v[114:115], v[114:115], v[104:105], v[104:105]
  v_pk_fma_f32 v[116:117], v[116:117], v[104:105], v[104:105]
  v_pk_fma_f32 v[118:119], v[118:119], v[104:105], v[104:105]
  v_rcp_f32 v112, v112
  v_rcp_f32 v113, v113
  v_rcp_f32 v114, v114
  v_rcp_f32 v115, v115
  v_rcp_f32 v116, v116
  v_rcp_f32 v117, v117
  v_rcp_f32 v118, v118
  v_rcp_f32 v119, v119
  v_pk_mul_f32 v[80:81], v[80:81], v[112:113]
  v_pk_mul_f32 v[82:83], v[82:83], v[114:115]
  v_pk_mul_f32 v[84:85], v[84:85], v[116:117]
  v_pk_mul_f32 v[86:87], v[86:87], v[118:119]
  v_cvt_pk_bf16_f32 v244, v80, v81
  v_cvt_pk_bf16_f32 v246, v84, v85
  v_cvt_pk_bf16_f32 v245, v82, v83
  v_cvt_pk_bf16_f32 v247, v86, v87
  v_permlane16_swap_b32 v244, v246
  s_nop 0
  v_permlane16_swap_b32 v245, v247
  buffer_store_dwordx4 v[244:247], v23, s[24:27], s60 offen offset:1024 sc1
  v_mov_b32 v4, s44
  v_mov_b32 v5, s45
  s_setprio 0
  v_lshl_add_u32 v32, v8, 3, v9
  v_lshlrev_b32 v32, 7, v32
  v_lshl_add_u32 v32, v10, 3, v32
  v_lshrrev_b32 v33, 1, v9
  v_lshl_or_b32 v33, v11, 1, v33
  v_lshl_add_u32 v32, v33, 5, v32
  s_lshl_b32 s54, s56, 12
  v_add_u32 v32, s54, v32
  v_xor_b32 v33, 32, v32
  v_xor_b32 v34, 64, v32
  v_xor_b32 v35, 96, v32
  v_add_u32 v36, 0x10000, v32
  v_add_u32 v40, 0x20000, v32
  v_add_u32 v37, 0x10000, v33
  v_add_u32 v41, 0x20000, v33
  v_add_u32 v38, 0x10000, v34
  v_add_u32 v42, 0x20000, v34
  v_add_u32 v39, 0x10000, v35
  v_add_u32 v43, 0x20000, v35
  s_waitcnt vmcnt(0)
  s_mov_b64 exec, 1
  buffer_store_dwordx2 v[4:5], v7, s[24:27], s53 offen
  s_mov_b64 exec, -1
  s_barrier
  ds_read_b64_tr_b16 v[48:49], v32 offset:32768
  ds_read_b64_tr_b16 v[50:51], v32 offset:33280
  ds_read_b64_tr_b16 v[52:53], v33 offset:32768
  ds_read_b64_tr_b16 v[54:55], v33 offset:33280
  ds_read_b64_tr_b16 v[56:57], v34 offset:32768
  ds_read_b64_tr_b16 v[58:59], v34 offset:33280
  ds_read_b64_tr_b16 v[60:61], v35 offset:32768
  ds_read_b64_tr_b16 v[62:63], v35 offset:33280
  ds_read_b64_tr_b16 v[64:65], v32 offset:40960
  ds_read_b64_tr_b16 v[66:67], v32 offset:41472
  ds_read_b64_tr_b16 v[68:69], v33 offset:40960
  ds_read_b64_tr_b16 v[70:71], v33 offset:41472
  ds_read_b64_tr_b16 v[72:73], v34 offset:40960
  ds_read_b64_tr_b16 v[74:75], v34 offset:41472
  ds_read_b64_tr_b16 v[76:77], v35 offset:40960
  ds_read_b64_tr_b16 v[78:79], v35 offset:41472
  ds_read_b64_tr_b16 v[80:81], v32 offset:49152
  ds_read_b64_tr_b16 v[82:83], v32 offset:49664
  ds_read_b64_tr_b16 v[84:85], v33 offset:49152
  ds_read_b64_tr_b16 v[86:87], v33 offset:49664
  ds_read_b64_tr_b16 v[88:89], v34 offset:49152
  ds_read_b64_tr_b16 v[90:91], v34 offset:49664
  ds_read_b64_tr_b16 v[92:93], v35 offset:49152
  ds_read_b64_tr_b16 v[94:95], v35 offset:49664
  ds_read_b64_tr_b16 v[96:97], v32 offset:57344
  ds_read_b64_tr_b16 v[98:99], v32 offset:57856
  ds_read_b64_tr_b16 v[100:101], v33 offset:57344
  ds_read_b64_tr_b16 v[102:103], v33 offset:57856
  ds_read_b64_tr_b16 v[104:105], v34 offset:57344
  ds_read_b64_tr_b16 v[106:107], v34 offset:57856
  ds_read_b64_tr_b16 v[108:109], v35 offset:57344
  ds_read_b64_tr_b16 v[110:111], v35 offset:57856
  ds_read_b64_tr_b16 v[112:113], v32 offset:0
  ds_read_b64_tr_b16 v[114:115], v32 offset:512
  ds_read_b64_tr_b16 v[116:117], v33 offset:0
  ds_read_b64_tr_b16 v[118:119], v33 offset:512
  ds_read_b64_tr_b16 v[120:121], v34 offset:0
  ds_read_b64_tr_b16 v[122:123], v34 offset:512
  ds_read_b64_tr_b16 v[124:125], v35 offset:0
  ds_read_b64_tr_b16 v[126:127], v35 offset:512
  ds_read_b64_tr_b16 v[128:129], v32 offset:8192
  ds_read_b64_tr_b16 v[130:131], v32 offset:8704
  ds_read_b64_tr_b16 v[132:133], v33 offset:8192
  ds_read_b64_tr_b16 v[134:135], v33 offset:8704
  ds_read_b64_tr_b16 v[136:137], v34 offset:8192
  ds_read_b64_tr_b16 v[138:139], v34 offset:8704
  ds_read_b64_tr_b16 v[140:141], v35 offset:8192
  ds_read_b64_tr_b16 v[142:143], v35 offset:8704
  ds_read_b64_tr_b16 v[144:145], v36 offset:0
  ds_read_b64_tr_b16 v[146:147], v36 offset:512
  ds_read_b64_tr_b16 v[148:149], v37 offset:0
  ds_read_b64_tr_b16 v[150:151], v37 offset:512
  ds_read_b64_tr_b16 v[152:153], v38 offset:0
  ds_read_b64_tr_b16 v[154:155], v38 offset:512
  ds_read_b64_tr_b16 v[156:157], v39 offset:0
  ds_read_b64_tr_b16 v[158:159], v39 offset:512
  ds_read_b64_tr_b16 v[160:161], v36 offset:8192
  ds_read_b64_tr_b16 v[162:163], v36 offset:8704
  ds_read_b64_tr_b16 v[164:165], v37 offset:8192
  ds_read_b64_tr_b16 v[166:167], v37 offset:8704
  ds_read_b64_tr_b16 v[168:169], v38 offset:8192
  ds_read_b64_tr_b16 v[170:171], v38 offset:8704
  ds_read_b64_tr_b16 v[172:173], v39 offset:8192
  ds_read_b64_tr_b16 v[174:175], v39 offset:8704
  ds_read_b64_tr_b16 v[176:177], v36 offset:16384
  ds_read_b64_tr_b16 v[178:179], v36 offset:16896
  ds_read_b64_tr_b16 v[180:181], v37 offset:16384
  ds_read_b64_tr_b16 v[182:183], v37 offset:16896
  ds_read_b64_tr_b16 v[184:185], v38 offset:16384
  ds_read_b64_tr_b16 v[186:187], v38 offset:16896
  ds_read_b64_tr_b16 v[188:189], v39 offset:16384
  ds_read_b64_tr_b16 v[190:191], v39 offset:16896
  ds_read_b64_tr_b16 v[192:193], v36 offset:24576
  ds_read_b64_tr_b16 v[194:195], v36 offset:25088
  ds_read_b64_tr_b16 v[196:197], v37 offset:24576
  ds_read_b64_tr_b16 v[198:199], v37 offset:25088
  ds_read_b64_tr_b16 v[200:201], v38 offset:24576
  ds_read_b64_tr_b16 v[202:203], v38 offset:25088
  ds_read_b64_tr_b16 v[204:205], v39 offset:24576
  ds_read_b64_tr_b16 v[206:207], v39 offset:25088
  ds_read_b64_tr_b16 v[208:209], v40 offset:24576
  ds_read_b64_tr_b16 v[210:211], v40 offset:25088
  ds_read_b64_tr_b16 v[212:213], v41 offset:24576
  ds_read_b64_tr_b16 v[214:215], v41 offset:25088
  ds_read_b64_tr_b16 v[216:217], v42 offset:24576
  ds_read_b64_tr_b16 v[218:219], v42 offset:25088
  ds_read_b64_tr_b16 v[220:221], v43 offset:24576
  ds_read_b64_tr_b16 v[222:223], v43 offset:25088
  s_lshl_b32 s52, s98, 9
  s_add_u32 s52, s52, 6815744
  v_and_b32 v5, 31, v2
  v_lshlrev_b32 v5, 3, v5
  v_lshlrev_b32 v1, 4, v2
  s_lshr_b32 s58, s41, 3
  s_lshl_b32 s58, s58, 2
  s_lshl_b32 s59, s57, 1
  s_add_u32 s58, s58, s59
  s_add_u32 s59, s58, 1
  s_sub_u32 s59, s59, s56
  s_add_u32 s58, s58, s56
  s_mul_i32 s58, s58, 43
  s_mul_i32 s59, s59, 43
  s_add_u32 s58, s58, s56
  s_add_u32 s59, s59, s56
  s_lshl_b32 s58, s58, 10
  s_lshl_b32 s59, s59, 10
  s_mul_i32 s54, s40, 720896
  s_add_u32 s58, s58, s54
  s_add_u32 s59, s59, s54
  s_waitcnt lgkmcnt(0)
  s_barrier
  s_add_u32 s51, s58, 2048
  buffer_load_dwordx4 v[16:19], v1, s[24:27], s51 offen sc1
  s_add_u32 s51, s59, 2048
  buffer_load_dwordx4 v[20:23], v1, s[24:27], s51 offen sc1
  s_add_u32 s51, s58, 6144
  buffer_load_dwordx4 v[24:27], v1, s[24:27], s51 offen sc1
  s_add_u32 s51, s59, 6144
  buffer_load_dwordx4 v[28:31], v1, s[24:27], s51 offen sc1
  s_add_u32 s51, s58, 10240
  buffer_load_dwordx4 v[32:35], v1, s[24:27], s51 offen sc1
  s_add_u32 s51, s59, 10240
  buffer_load_dwordx4 v[36:39], v1, s[24:27], s51 offen sc1
  s_add_u32 s51, s58, 14336
  buffer_load_dwordx4 v[40:43], v1, s[24:27], s51 offen sc1
  s_add_u32 s51, s59, 14336
  buffer_load_dwordx4 v[44:47], v1, s[24:27], s51 offen sc1
  s_waitcnt vmcnt(7)
  v_mfma_f32_16x16x32_bf16 v[224:227], v[48:51], v[16:19], 0
  v_mfma_f32_16x16x32_bf16 v[228:231], v[52:55], v[16:19], 0
  v_mfma_f32_16x16x32_bf16 v[232:235], v[56:59], v[16:19], 0
  v_mfma_f32_16x16x32_bf16 v[236:239], v[60:63], v[16:19], 0
  s_waitcnt vmcnt(6)
  v_mfma_f32_16x16x32_bf16 v[240:243], v[48:51], v[20:23], 0
  v_mfma_f32_16x16x32_bf16 v[244:247], v[52:55], v[20:23], 0
  v_mfma_f32_16x16x32_bf16 v[248:251], v[56:59], v[20:23], 0
  v_mfma_f32_16x16x32_bf16 v[252:255], v[60:63], v[20:23], 0
  s_add_u32 s51, s58, 18432
  buffer_load_dwordx4 v[16:19], v1, s[24:27], s51 offen sc1
  s_add_u32 s51, s59, 18432
  buffer_load_dwordx4 v[20:23], v1, s[24:27], s51 offen sc1
  s_waitcnt vmcnt(7)
  v_mfma_f32_16x16x32_bf16 v[224:227], v[64:67], v[24:27], v[224:227]
  v_mfma_f32_16x16x32_bf16 v[228:231], v[68:71], v[24:27], v[228:231]
  v_mfma_f32_16x16x32_bf16 v[232:235], v[72:75], v[24:27], v[232:235]
  v_mfma_f32_16x16x32_bf16 v[236:239], v[76:79], v[24:27], v[236:239]
  s_waitcnt vmcnt(6)
  v_mfma_f32_16x16x32_bf16 v[240:243], v[64:67], v[28:31], v[240:243]
  v_mfma_f32_16x16x32_bf16 v[244:247], v[68:71], v[28:31], v[244:247]
  v_mfma_f32_16x16x32_bf16 v[248:251], v[72:75], v[28:31], v[248:251]
  v_mfma_f32_16x16x32_bf16 v[252:255], v[76:79], v[28:31], v[252:255]
  s_add_u32 s51, s58, 22528
  buffer_load_dwordx4 v[24:27], v1, s[24:27], s51 offen sc1
  s_add_u32 s51, s59, 22528
  buffer_load_dwordx4 v[28:31], v1, s[24:27], s51 offen sc1
  s_waitcnt vmcnt(7)
  v_mfma_f32_16x16x32_bf16 v[224:227], v[80:83], v[32:35], v[224:227]
  v_mfma_f32_16x16x32_bf16 v[228:231], v[84:87], v[32:35], v[228:231]
  v_mfma_f32_16x16x32_bf16 v[232:235], v[88:91], v[32:35], v[232:235]
  v_mfma_f32_16x16x32_bf16 v[236:239], v[92:95], v[32:35], v[236:239]
  s_waitcnt vmcnt(6)
  v_mfma_f32_16x16x32_bf16 v[240:243], v[80:83], v[36:39], v[240:243]
  v_mfma_f32_16x16x32_bf16 v[244:247], v[84:87], v[36:39], v[244:247]
  v_mfma_f32_16x16x32_bf16 v[248:251], v[88:91], v[36:39], v[248:251]
  v_mfma_f32_16x16x32_bf16 v[252:255], v[92:95], v[36:39], v[252:255]
  s_add_u32 s51, s58, 26624
  buffer_load_dwordx4 v[32:35], v1, s[24:27], s51 offen sc1
  s_add_u32 s51, s59, 26624
  buffer_load_dwordx4 v[36:39], v1, s[24:27], s51 offen sc1
  s_waitcnt vmcnt(7)
  v_mfma_f32_16x16x32_bf16 v[224:227], v[96:99], v[40:43], v[224:227]
  v_mfma_f32_16x16x32_bf16 v[228:231], v[100:103], v[40:43], v[228:231]
  v_mfma_f32_16x16x32_bf16 v[232:235], v[104:107], v[40:43], v[232:235]
  v_mfma_f32_16x16x32_bf16 v[236:239], v[108:111], v[40:43], v[236:239]
  s_waitcnt vmcnt(6)
  v_mfma_f32_16x16x32_bf16 v[240:243], v[96:99], v[44:47], v[240:243]
  v_mfma_f32_16x16x32_bf16 v[244:247], v[100:103], v[44:47], v[244:247]
  v_mfma_f32_16x16x32_bf16 v[248:251], v[104:107], v[44:47], v[248:251]
  v_mfma_f32_16x16x32_bf16 v[252:255], v[108:111], v[44:47], v[252:255]
  s_add_u32 s51, s58, 30720
  buffer_load_dwordx4 v[40:43], v1, s[24:27], s51 offen sc1
  s_add_u32 s51, s59, 30720
  buffer_load_dwordx4 v[44:47], v1, s[24:27], s51 offen sc1
  s_waitcnt vmcnt(7)
  v_mfma_f32_16x16x32_bf16 v[224:227], v[112:115], v[16:19], v[224:227]
  v_mfma_f32_16x16x32_bf16 v[228:231], v[116:119], v[16:19], v[228:231]
  v_mfma_f32_16x16x32_bf16 v[232:235], v[120:123], v[16:19], v[232:235]
  v_mfma_f32_16x16x32_bf16 v[236:239], v[124:127], v[16:19], v[236:239]
  s_waitcnt vmcnt(6)
  v_mfma_f32_16x16x32_bf16 v[240:243], v[112:115], v[20:23], v[240:243]
  v_mfma_f32_16x16x32_bf16 v[244:247], v[116:119], v[20:23], v[244:247]
  v_mfma_f32_16x16x32_bf16 v[248:251], v[120:123], v[20:23], v[248:251]
  v_mfma_f32_16x16x32_bf16 v[252:255], v[124:127], v[20:23], v[252:255]
  s_add_u32 s51, s58, 34816
  buffer_load_dwordx4 v[16:19], v1, s[24:27], s51 offen sc1
  s_add_u32 s51, s59, 34816
  buffer_load_dwordx4 v[20:23], v1, s[24:27], s51 offen sc1
  s_waitcnt vmcnt(7)
  v_mfma_f32_16x16x32_bf16 v[224:227], v[128:131], v[24:27], v[224:227]
  v_mfma_f32_16x16x32_bf16 v[228:231], v[132:135], v[24:27], v[228:231]
  v_mfma_f32_16x16x32_bf16 v[232:235], v[136:139], v[24:27], v[232:235]
  v_mfma_f32_16x16x32_bf16 v[236:239], v[140:143], v[24:27], v[236:239]
  s_waitcnt vmcnt(6)
  v_mfma_f32_16x16x32_bf16 v[240:243], v[128:131], v[28:31], v[240:243]
  v_mfma_f32_16x16x32_bf16 v[244:247], v[132:135], v[28:31], v[244:247]
  v_mfma_f32_16x16x32_bf16 v[248:251], v[136:139], v[28:31], v[248:251]
  v_mfma_f32_16x16x32_bf16 v[252:255], v[140:143], v[28:31], v[252:255]
  s_add_u32 s51, s58, 38912
  buffer_load_dwordx4 v[24:27], v1, s[24:27], s51 offen sc1
  s_add_u32 s51, s59, 38912
  buffer_load_dwordx4 v[28:31], v1, s[24:27], s51 offen sc1
  s_waitcnt vmcnt(7)
  v_mfma_f32_16x16x32_bf16 v[224:227], v[144:147], v[32:35], v[224:227]
  v_mfma_f32_16x16x32_bf16 v[228:231], v[148:151], v[32:35], v[228:231]
  v_mfma_f32_16x16x32_bf16 v[232:235], v[152:155], v[32:35], v[232:235]
  v_mfma_f32_16x16x32_bf16 v[236:239], v[156:159], v[32:35], v[236:239]
  s_waitcnt vmcnt(6)
  v_mfma_f32_16x16x32_bf16 v[240:243], v[144:147], v[36:39], v[240:243]
  v_mfma_f32_16x16x32_bf16 v[244:247], v[148:151], v[36:39], v[244:247]
  v_mfma_f32_16x16x32_bf16 v[248:251], v[152:155], v[36:39], v[248:251]
  v_mfma_f32_16x16x32_bf16 v[252:255], v[156:159], v[36:39], v[252:255]
  s_add_u32 s51, s58, 43008
  buffer_load_dwordx4 v[32:35], v1, s[24:27], s51 offen sc1
  s_add_u32 s51, s59, 43008
  buffer_load_dwordx4 v[36:39], v1, s[24:27], s51 offen sc1
  s_waitcnt vmcnt(7)
  v_mfma_f32_16x16x32_bf16 v[224:227], v[160:163], v[40:43], v[224:227]
  v_mfma_f32_16x16x32_bf16 v[228:231], v[164:167], v[40:43], v[228:231]
  v_mfma_f32_16x16x32_bf16 v[232:235], v[168:171], v[40:43], v[232:235]
  v_mfma_f32_16x16x32_bf16 v[236:239], v[172:175], v[40:43], v[236:239]
  s_waitcnt vmcnt(6)
  v_mfma_f32_16x16x32_bf16 v[240:243], v[160:163], v[44:47], v[240:243]
  v_mfma_f32_16x16x32_bf16 v[244:247], v[164:167], v[44:47], v[244:247]
  v_mfma_f32_16x16x32_bf16 v[248:251], v[168:171], v[44:47], v[248:251]
  v_mfma_f32_16x16x32_bf16 v[252:255], v[172:175], v[44:47], v[252:255]
  s_waitcnt vmcnt(5)
  v_mfma_f32_16x16x32_bf16 v[224:227], v[176:179], v[16:19], v[224:227]
  v_mfma_f32_16x16x32_bf16 v[228:231], v[180:183], v[16:19], v[228:231]
  v_mfma_f32_16x16x32_bf16 v[232:235], v[184:187], v[16:19], v[232:235]
  v_mfma_f32_16x16x32_bf16 v[236:239], v[188:191], v[16:19], v[236:239]
  s_waitcnt vmcnt(4)
  v_mfma_f32_16x16x32_bf16 v[240:243], v[176:179], v[20:23], v[240:243]
  v_mfma_f32_16x16x32_bf16 v[244:247], v[180:183], v[20:23], v[244:247]
  v_mfma_f32_16x16x32_bf16 v[248:251], v[184:187], v[20:23], v[248:251]
  v_mfma_f32_16x16x32_bf16 v[252:255], v[188:191], v[20:23], v[252:255]
  s_waitcnt vmcnt(3)
  v_mfma_f32_16x16x32_bf16 v[224:227], v[192:195], v[24:27], v[224:227]
  v_mfma_f32_16x16x32_bf16 v[228:231], v[196:199], v[24:27], v[228:231]
  v_mfma_f32_16x16x32_bf16 v[232:235], v[200:203], v[24:27], v[232:235]
  v_mfma_f32_16x16x32_bf16 v[236:239], v[204:207], v[24:27], v[236:239]
  s_waitcnt vmcnt(2)
  v_mfma_f32_16x16x32_bf16 v[240:243], v[192:195], v[28:31], v[240:243]
  v_mfma_f32_16x16x32_bf16 v[244:247], v[196:199], v[28:31], v[244:247]
  v_mfma_f32_16x16x32_bf16 v[248:251], v[200:203], v[28:31], v[248:251]
  v_mfma_f32_16x16x32_bf16 v[252:255], v[204:207], v[28:31], v[252:255]
  s_cmp_eq_u32 s56, 1
  s_cbranch_scc1 L_sequential_preLN__ssm_conv_h3__dense_activation_silu__prompt_kernel_34
  s_waitcnt vmcnt(1)
  v_mfma_f32_16x16x32_bf16 v[224:227], v[208:211], v[32:35], v[224:227]
  v_mfma_f32_16x16x32_bf16 v[228:231], v[212:215], v[32:35], v[228:231]
  v_mfma_f32_16x16x32_bf16 v[232:235], v[216:219], v[32:35], v[232:235]
  v_mfma_f32_16x16x32_bf16 v[236:239], v[220:223], v[32:35], v[236:239]
  s_waitcnt vmcnt(0)
  v_mfma_f32_16x16x32_bf16 v[240:243], v[208:211], v[36:39], v[240:243]
  v_mfma_f32_16x16x32_bf16 v[244:247], v[212:215], v[36:39], v[244:247]
  v_mfma_f32_16x16x32_bf16 v[248:251], v[216:219], v[36:39], v[248:251]
  v_mfma_f32_16x16x32_bf16 v[252:255], v[220:223], v[36:39], v[252:255]
L_sequential_preLN__ssm_conv_h3__dense_activation_silu__prompt_kernel_34:
  s_mul_i32 s53, s42, 6144
  v_add_u32 v48, s53, v1
  s_xor_b32 s53, s42, 2
  s_mul_i32 s53, s53, 6144
  s_add_u32 s53, s53, 0
  v_add_u32 v49, s53, v1
  s_xor_b32 s53, s42, 4
  s_mul_i32 s53, s53, 6144
  s_add_u32 s53, s53, 2048
  v_add_u32 v50, s53, v1
  s_xor_b32 s53, s42, 6
  s_mul_i32 s53, s53, 6144
  s_add_u32 s53, s53, 4096
  v_add_u32 v51, s53, v1
  ds_write_b128 v48, v[232:235] offset:2048
  ds_write_b128 v48, v[236:239] offset:3072
  ds_write_b128 v48, v[240:243] offset:0
  ds_write_b128 v48, v[244:247] offset:1024
  ds_write_b128 v48, v[248:251] offset:4096
  ds_write_b128 v48, v[252:255] offset:5120
  v_and_b32 v52, 15, v2
  v_lshlrev_b32 v52, 10, v52
  v_lshl_add_u32 v52, v11, 5, v52
  v_lshrrev_b32 v53, 1, v8
  v_lshl_add_u32 v52, v53, 4, v52
  s_lshl_b32 s58, s98, 16
  s_lshl_b32 s59, s66, 14
  s_add_u32 s58, s58, s59
  s_lshl_b32 s59, s99, 7
  s_add_u32 s58, s58, s59
  v_lshlrev_b32 v56, 16, v12
  v_and_b32 v57, s79, v12
  v_lshlrev_b32 v58, 16, v13
  v_and_b32 v59, s79, v13
  v_lshlrev_b32 v60, 16, v14
  v_and_b32 v61, s79, v14
  v_lshlrev_b32 v62, 16, v15
  v_and_b32 v63, s79, v15
  v_add_f32 v56, v56, v224
  v_add_f32 v57, v57, v225
  v_add_f32 v58, v58, v226
  v_add_f32 v59, v59, v227
  v_add_f32 v60, v60, v228
  v_add_f32 v61, v61, v229
  v_add_f32 v62, v62, v230
  v_add_f32 v63, v63, v231
  s_waitcnt lgkmcnt(0)
  s_barrier
  ds_read_b128 v[64:67], v49
  ds_read_b128 v[68:71], v49 offset:1024
  ds_read_b128 v[72:75], v50
  ds_read_b128 v[76:79], v50 offset:1024
  ds_read_b128 v[80:83], v51
  ds_read_b128 v[84:87], v51 offset:1024
  s_waitcnt lgkmcnt(4)
  v_pk_add_f32 v[56:57], v[56:57], v[64:65]
  v_pk_add_f32 v[58:59], v[58:59], v[66:67]
  v_pk_add_f32 v[60:61], v[60:61], v[68:69]
  v_pk_add_f32 v[62:63], v[62:63], v[70:71]
  s_waitcnt lgkmcnt(2)
  v_pk_add_f32 v[56:57], v[56:57], v[72:73]
  v_pk_add_f32 v[58:59], v[58:59], v[74:75]
  v_pk_add_f32 v[60:61], v[60:61], v[76:77]
  v_pk_add_f32 v[62:63], v[62:63], v[78:79]
  s_waitcnt lgkmcnt(0)
  v_pk_add_f32 v[56:57], v[56:57], v[80:81]
  v_pk_add_f32 v[58:59], v[58:59], v[82:83]
  v_pk_add_f32 v[60:61], v[60:61], v[84:85]
  v_pk_add_f32 v[62:63], v[62:63], v[86:87]
  v_cvt_pk_bf16_f32 v88, v56, v57
  v_cvt_pk_bf16_f32 v89, v58, v59
  v_cvt_pk_bf16_f32 v90, v60, v61
  v_cvt_pk_bf16_f32 v91, v62, v63
  s_nop 1
  v_permlane16_swap_b32 v88, v90
  v_permlane16_swap_b32 v89, v91
  s_nop 0
  buffer_store_dwordx4 v[88:91], v52, s[16:19], s58 offen offset:0
  s_branch L_fin
L_B:
  s_setprio 1
  s_mov_b32 s8, s28
  s_mov_b32 s9, s29
  s_mov_b32 s10, 2097152
  s_mov_b32 s11, 0x00020000
  s_add_u32 s4, s44, s60
  s_addc_u32 s5, s45, 0
  s_mov_b32 s6, 4096
  s_mov_b32 s7, 0x00020000
  s_lshl_b32 s54, s2, 3
  s_add_u32 s54, s54, s42
  s_cmp_lg_u32 s54, 7
  s_cbranch_scc1 L_sequential_preLN__ssm_conv_h3__dense_activation_silu__prompt_kernel_35
  s_memrealtime s[54:55]
  s_waitcnt lgkmcnt(0)
  s_or_b32 s55, s55, 0x40000000
  v_mov_b32 v16, s54
  v_mov_b32 v17, s55
  s_mov_b64 exec, 1
  buffer_store_dwordx2 v[16:17], v27, s[68:71], 0 offen sc1
  s_mov_b64 exec, -1
L_sequential_preLN__ssm_conv_h3__dense_activation_silu__prompt_kernel_35:
  s_lshl_b32 s53, s2, 3
  s_add_u32 m0, s51, 82944
  s_lshl_b32 s50, s43, 1
  buffer_load_dwordx4 v5, s[8:11], s49 offen lds
  s_add_u32 m0, s51, 87040
  s_add_u32 s53, s53, s50
  buffer_load_dwordx4 v5, s[8:11], s52 offen lds
  s_lshl_b32 s50, s53, 10
  buffer_load_dwordx4 v[104:107], v24, s[8:11], s50 offen
  buffer_load_dwordx4 v[108:111], v24, s[8:11], s50 offen offset:1024
  s_lshl_b32 s50, s57, 11
  s_add_u32 s73, s50, s61
  s_add_u32 m0, s73, 12528
  v_add_u32 v113, s73, v24
  buffer_load_dwordx4 v24, s[4:7], s50 offen lds
  buffer_load_dwordx4 v24, s[4:7], s50 offen offset:1024 lds
  s_lshl_b32 s50, s43, 6
  v_add_u32 v6, s50, v2
  v_lshlrev_b32 v14, 7, v6
  v_cmp_gt_u32 vcc, 88, v6
  v_add_u32 v15, 32768, v14
  v_mov_b32 v16, 0x7ffffff0
  v_cndmask_b32 v15, v16, v15, vcc
  v_lshrrev_b32 v114, 2, v2
  v_and_b32 v115, 3, v2
  v_mul_u32_u24 v115, 4160, v115
  v_lshl_add_u32 v115, v114, 4, v115
  v_add_u32 v115, s61, v115
  s_mov_b64 exec, 0xfff
  ds_write_b128 v115, v[30:33]
  s_mov_b64 exec, -1
  s_lshl_b32 s50, s58, 1
  s_add_u32 s46, s46, s50
  s_addc_u32 s47, s47, 0
  s_load_dword s55, s[46:47], 0
  s_load_dwordx2 s[32:33], s[0:1], 72
  v_lshrrev_b32 v8, 4, v2
  v_bfe_u32 v9, v2, 2, 2
  v_and_b32 v10, 3, v2
  v_and_b32 v11, 1, v8
  v_lshl_add_u32 v12, v11, 2, v10
  s_lshr_b32 s72, s42, 2
  s_lshl_b32 s72, s72, 16
  s_add_u32 s72, s72, 6553600
  s_lshl_b32 s62, s40, 2
  s_lshr_b32 s63, s41, 3
  s_add_u32 s63, s63, s62
  s_lshl_b32 s63, s63, 8
  s_add_u32 s63, s63, s72
  s_add_u32 s62, s62, s43
  s_lshl_b32 s62, s62, 5
  s_add_u32 s62, s62, s41
  s_lshl_b32 s62, s62, 3
  s_add_u32 s62, s62, s72
  s_add_u32 s74, s62, 0x8000
  v_and_b32 v25, 31, v2
  v_lshlrev_b32 v25, 3, v25
  buffer_load_dwordx2 v[28:29], v25, s[24:27], s63 offen sc1
  s_lshr_b32 s50, s42, 2
  s_lshl_b32 s50, s50, 18
  s_add_u32 s50, s50, s59
  s_lshl_b32 s72, s57, 11
  s_add_u32 s50, s50, s72
  v_lshlrev_b32 v40, 7, v2
  s_cmp_ge_u32 s42, 4
  s_cselect_b32 s50, 0x40000000, s50
  s_cmp_lt_u32 s42, 4
  s_cselect_b32 s50, 0x40000000, s50
  s_mov_b64 exec, 0xffff
  buffer_load_dword v254, v40, s[24:27], s50 offen
  s_mov_b64 exec, -1
  v_lshrrev_b32 v40, 1, v8
  v_lshl_add_u32 v40, v40, 2, v10
  v_lshl_add_u32 v41, v40, 3, v9
  v_lshlrev_b32 v41, 7, v41
  v_lshl_add_u32 v41, v11, 3, v41
  v_add_u32 v41, 65536, v41
  v_lshrrev_b32 v42, 1, v9
  v_lshl_or_b32 v43, v10, 1, v42
  s_lshl_b32 s50, s43, 1
  v_xor_b32 v43, s50, v43
  v_lshl_add_u32 v43, v43, 4, v41
  v_xor_b32 v45, 16, v43
  v_lshrrev_b32 v47, 1, v8
  v_lshl_add_u32 v47, v47, 2, v9
  v_and_b32 v48, 3, v12
  v_lshlrev_b32 v48, 1, v48
  v_xor_b32 v47, v47, v48
  v_lshlrev_b32 v48, 7, v12
  v_lshl_add_u32 v47, v47, 4, v48
  v_and_b32 v49, 3, v3
  v_lshlrev_b32 v49, 1, v49
  v_xor_b32 v49, v4, v49
  v_lshlrev_b32 v49, 4, v49
  v_lshl_add_u32 v49, v3, 7, v49
  s_lshl_b32 s75, s42, 11
  s_add_u32 s75, s75, 91136
  v_add_u32 v49, s75, v49
  v_lshlrev_b32 v50, 12, v3
  v_lshl_add_u32 v50, v4, 4, v50
  s_mul_i32 s76, s40, 720896
  s_lshl_b32 s77, s43, 16
  s_add_u32 s76, s76, s77
  v_add_u32 v47, s75, v47
  s_lshl_b32 s98, s40, 2
  s_lshr_b32 s99, s41, 3
  s_add_u32 s98, s98, s99
  s_and_b32 s99, s41, 7
  s_mul_i32 s100, s99, 11
  s_min_u32 s100, s100, 75
  s_movk_i32 s50, 2979
  v_add_u32 v116, 0, v2
  v_mul_u32_u24 v117, s50, v116
  v_lshrrev_b32 v117, 16, v117
  v_mul_u32_u24 v118, 22, v117
  v_sub_u32 v118, v116, v118
  v_mul_u32_u24 v117, 2752, v117
  v_lshl_add_u32 v20, v118, 4, v117
  v_add_u32 v116, 64, v2
  v_mul_u32_u24 v117, s50, v116
  v_lshrrev_b32 v117, 16, v117
  v_mul_u32_u24 v118, 22, v117
  v_sub_u32 v118, v116, v118
  v_mul_u32_u24 v117, 2752, v117
  v_lshl_add_u32 v21, v118, 4, v117
  v_subrev_u32 v21, 1024, v21
  v_add_u32 v116, 128, v2
  v_mul_u32_u24 v117, s50, v116
  v_lshrrev_b32 v117, 16, v117
  v_mul_u32_u24 v118, 22, v117
  v_sub_u32 v118, v116, v118
  v_mul_u32_u24 v117, 2752, v117
  v_lshl_add_u32 v22, v118, 4, v117
  v_subrev_u32 v22, 2048, v22
  v_and_b32 v116, 2, v3
  v_xor_b32 v116, v4, v116
  s_lshl_b32 s50, s57, 2
  v_xor_b32 v116, s50, v116
  v_lshlrev_b32 v23, 10, v3
  v_lshl_add_u32 v23, v116, 4, v23
  s_waitcnt vmcnt(2) lgkmcnt(0)
  s_mov_b64 exec, 1
  ds_add_u32 v34, v39 offset:0
  s_mov_b64 exec, -1
  buffer_load_dwordx2 v[18:19], v27, s[68:71], 0 offen sc1
  s_mov_b32 s3, 0x3f803f80
  v_dot2_f32_bf16 v60, v104, s3, 0
  v_dot2_f32_bf16 v61, v104, v104, 0
  v_dot2_f32_bf16 v62, v108, s3, 0
  v_dot2_f32_bf16 v63, v108, v108, 0
  v_dot2_f32_bf16 v60, v105, s3, v60
  v_dot2_f32_bf16 v61, v105, v105, v61
  v_dot2_f32_bf16 v62, v109, s3, v62
  v_dot2_f32_bf16 v63, v109, v109, v63
  v_dot2_f32_bf16 v60, v106, s3, v60
  v_dot2_f32_bf16 v61, v106, v106, v61
  v_dot2_f32_bf16 v62, v110, s3, v62
  v_dot2_f32_bf16 v63, v110, v110, v63
  v_dot2_f32_bf16 v60, v107, s3, v60
  v_dot2_f32_bf16 v61, v107, v107, v61
  v_dot2_f32_bf16 v62, v111, s3, v62
  v_dot2_f32_bf16 v63, v111, v111, v63
  s_mov_b32 s3, 0
L_sequential_preLN__ssm_conv_h3__dense_activation_silu__prompt_kernel_36:
  ds_read_b32 v38, v34 offset:0
  s_add_u32 s3, s3, 1
  s_waitcnt lgkmcnt(0)
  v_readfirstlane_b32 s50, v38
  s_cmp_ge_u32 s50, 4
  s_cbranch_scc1 L_sequential_preLN__ssm_conv_h3__dense_activation_silu__prompt_kernel_37
  s_cmp_lt_u32 s3, 2097152
  s_cbranch_scc1 L_sequential_preLN__ssm_conv_h3__dense_activation_silu__prompt_kernel_36
L_sequential_preLN__ssm_conv_h3__dense_activation_silu__prompt_kernel_37:
  ds_read_b64_tr_b16 v[52:53], v43 offset:17408
  ds_read_b64_tr_b16 v[54:55], v43 offset:17920
  ds_read_b64_tr_b16 v[56:57], v45 offset:17408
  ds_read_b64_tr_b16 v[58:59], v45 offset:17920
  ds_read_b64 v[120:121], v113 offset:12520
  ds_read_b128 v[122:125], v113 offset:12528
  ds_read_b64 v[128:129], v113 offset:13544
  ds_read_b128 v[130:133], v113 offset:13552
  v_permlane32_swap_b32 v60, v62
  v_permlane32_swap_b32 v61, v63
  s_lshl_b32 s77, s41, 7
  v_add_f32 v60, v60, v62
  v_add_f32 v61, v61, v63
  s_add_u32 s77, s77, s76
  v_add_f32_dpp v60, v60, v60 quad_perm:[1,0,3,2] row_mask:0xf bank_mask:0xf
  v_add_f32_dpp v61, v61, v61 quad_perm:[1,0,3,2] row_mask:0xf bank_mask:0xf
  s_waitcnt lgkmcnt(4)
  ds_write_b128 v47, v[52:55]
  ds_write_b128 v47, v[56:59] offset:1024
  ds_read_b128 v[100:103], v49
  ds_read_b128 v[104:107], v49 offset:1024
  v_add_f32_dpp v60, v60, v60 quad_perm:[2,3,0,1] row_mask:0xf bank_mask:0xf
  v_add_f32_dpp v61, v61, v61 quad_perm:[2,3,0,1] row_mask:0xf bank_mask:0xf
  s_add_u32 s77, s77, 262144
  v_add_f32_dpp v60, v60, v60 row_half_mirror row_mask:0xf bank_mask:0xf
  v_add_f32_dpp v61, v61, v61 row_half_mirror row_mask:0xf bank_mask:0xf
  s_add_u32 s78, s77, 32768
  v_add_f32_dpp v60, v60, v60 row_mirror row_mask:0xf bank_mask:0xf
  v_add_f32_dpp v61, v61, v61 row_mirror row_mask:0xf bank_mask:0xf
  s_nop 0
  v_add_f32_dpp v60, v60, v60 row_bcast:15 row_mask:0xa bank_mask:0xf
  v_add_f32_dpp v61, v61, v61 row_bcast:15 row_mask:0xa bank_mask:0xf
  s_nop 0
  v_mul_f32 v60, 0x3b000000, v60
  v_mul_f32 v61, 0x3b000000, v61
  v_fma_f32 v61, -v60, v60, v61
  v_max_f32 v61, 0, v61
  v_add_f32 v61, 0x3727c5ac, v61
  v_rsq_f32 v16, v61
  s_waitcnt lgkmcnt(0)
  buffer_store_dwordx4 v[100:103], v50, s[24:27], s77 offen sc1
  buffer_store_dwordx4 v[104:107], v50, s[24:27], s78 offen sc1
  v_mul_f32 v17, -v60, v16
  v_add_u32 v16, 0x80, v16
  v_add_u32 v17, 0x80, v17
  s_lshl_b32 s53, s53, 3
  v_readlane_b32 s4, v16, 31
  v_readlane_b32 s5, v17, 31
  v_readlane_b32 s6, v16, 63
  v_readlane_b32 s7, v17, 63
  s_add_u32 s53, s53, 6291456
  s_mov_b32 s3, 0
  s_waitcnt vmcnt(2)
  s_branch L_sequential_preLN__ssm_conv_h3__dense_activation_silu__prompt_kernel_40
L_sequential_preLN__ssm_conv_h3__dense_activation_silu__prompt_kernel_38:
  buffer_load_dwordx2 v[18:19], v27, s[68:71], 0 offen sc1
  s_add_u32 s3, s3, 1
  s_waitcnt vmcnt(0)
L_sequential_preLN__ssm_conv_h3__dense_activation_silu__prompt_kernel_40:
  v_readfirstlane_b32 s96, v18
  v_readfirstlane_b32 s97, v19
  s_cmp_lg_u32 s97, 0
  s_cbranch_scc1 L_sequential_preLN__ssm_conv_h3__dense_activation_silu__prompt_kernel_39
  s_cmp_lt_u32 s3, 32768
  s_cbranch_scc1 L_sequential_preLN__ssm_conv_h3__dense_activation_silu__prompt_kernel_38
L_sequential_preLN__ssm_conv_h3__dense_activation_silu__prompt_kernel_39:
  s_mov_b32 s44, s96
  s_xor_b32 s45, s97, s101
  v_mov_b32 v18, s44
  v_mov_b32 v19, s45
  s_and_b32 s4, s4, 0xffffff00
  s_bfe_u32 s3, s96, 524288
  s_or_b32 s4, s4, s3
  v_mov_b32 v108, s4
  s_and_b32 s5, s5, 0xffffff00
  s_bfe_u32 s3, s96, 524296
  s_or_b32 s5, s5, s3
  v_mov_b32 v109, s5
  s_and_b32 s6, s6, 0xffffff00
  s_bfe_u32 s3, s96, 524304
  s_or_b32 s6, s6, s3
  v_mov_b32 v110, s6
  s_and_b32 s7, s7, 0xffffff00
  s_bfe_u32 s3, s96, 524312
  s_or_b32 s7, s7, s3
  v_mov_b32 v111, s7
  s_mov_b64 exec, 1
  buffer_store_dwordx4 v[108:111], v27, s[24:27], s53 offen sc1
  s_mov_b64 exec, -1
  s_cmp_lt_u32 s43, 2
  s_cselect_b32 s20, s64, s66
  s_cselect_b32 s21, s65, s67
  s_mov_b32 s22, 1409024
  s_mov_b32 s23, 0x00020000
  s_mul_i32 s3, s2, 5504
  v_lshlrev_b32 v119, 7, v2
  s_mul_i32 s50, s57, 2752
  s_add_u32 s3, s3, s50
  s_mov_b64 exec, 0x7fffff
  buffer_load_dword v118, v119, s[20:23], s3 offen
  s_mov_b64 exec, -1
  v_alignbit_b32 v136, v121, v120, 16
  v_alignbit_b32 v137, v122, v121, 16
  v_alignbit_b32 v138, v123, v122, 16
  v_alignbit_b32 v139, v124, v123, 16
  v_mov_b32 v140, v121
  v_mov_b32 v141, v122
  v_mov_b32 v142, v123
  v_mov_b32 v143, v124
  v_alignbit_b32 v144, v122, v121, 16
  v_alignbit_b32 v145, v123, v122, 16
  v_alignbit_b32 v146, v124, v123, 16
  v_alignbit_b32 v147, v125, v124, 16
  ds_write_b128 v113, v[136:139] offset:48
  ds_write_b128 v113, v[140:143] offset:4208
  ds_write_b128 v113, v[144:147] offset:8368
  v_alignbit_b32 v148, v129, v128, 16
  v_alignbit_b32 v149, v130, v129, 16
  v_alignbit_b32 v150, v131, v130, 16
  v_alignbit_b32 v151, v132, v131, 16
  v_mov_b32 v152, v129
  v_mov_b32 v153, v130
  v_mov_b32 v154, v131
  v_mov_b32 v155, v132
  v_alignbit_b32 v156, v130, v129, 16
  v_alignbit_b32 v157, v131, v130, 16
  v_alignbit_b32 v158, v132, v131, 16
  v_alignbit_b32 v159, v133, v132, 16
  ds_write_b128 v113, v[148:151] offset:1072
  ds_write_b128 v113, v[152:155] offset:5232
  ds_write_b128 v113, v[156:159] offset:9392
  s_lshl_b32 s50, s43, 6
  v_add_u32 v6, s50, v2
  v_lshlrev_b32 v7, 4, v6
  s_waitcnt lgkmcnt(0)
  s_mov_b64 exec, 1
  ds_add_u32 v34, v39 offset:4
  ds_add_u32 v35, v39 offset:32
  s_waitcnt vmcnt(2)
  buffer_store_dwordx2 v[18:19], v27, s[24:27], s62 offen
  ds_add_u32 v34, v39 offset:28
  s_mov_b64 exec, -1
  s_lshl_b32 s77, s43, 12
  s_add_u32 s75, s77, 110592
  s_add_u32 s77, s77, 6291456
  v_add_u32 v12, s75, v24
  v_lshlrev_b32 v13, 6, v2
  v_add_u32 v13, s75, v13
  s_mov_b32 s4, 0x0c0c0400
  s_mov_b32 s5, 0x04000c0c
  s_mov_b32 s6, 0xffffff00
  s_setprio 0
  s_mov_b32 s8, s64
  s_mov_b32 s9, s65
  s_mov_b32 s10, 1409024
  s_mov_b32 s11, 0x00020000
  s_mov_b32 s12, s66
  s_mov_b32 s13, s67
  s_mov_b32 s14, 1409024
  s_mov_b32 s15, 0x00020000
  s_mov_b32 s16, s32
  s_mov_b32 s17, s33
  s_mov_b32 s18, 2097152
  s_mov_b32 s19, 0x00020000
  s_cmp_lg_u32 s43, 0
  s_cbranch_scc1 L_sequential_preLN__ssm_conv_h3__dense_activation_silu__prompt_kernel_44
  s_mov_b32 s22, 0
  s_mov_b64 s[48:49], 0
  s_mov_b32 s23, s63
  s_mov_b64 s[20:21], s[44:45]
  buffer_load_dwordx2 v[28:29], v25, s[24:27], s23 offen sc1
L_sequential_preLN__ssm_conv_h3__dense_activation_silu__prompt_kernel_47:
  buffer_load_dwordx2 v[36:37], v25, s[24:27], s23 offen sc1
  s_waitcnt vmcnt(1)
  v_cmp_eq_u64 vcc, s[20:21], v[28:29]
  s_add_u32 s22, s22, 1
  s_cmp_eq_u64 vcc, -1
  s_cbranch_scc1 L_sequential_preLN__ssm_conv_h3__dense_activation_silu__prompt_kernel_42
  buffer_load_dwordx2 v[28:29], v25, s[24:27], s23 offen sc1
  s_waitcnt vmcnt(1)
  v_cmp_eq_u64 vcc, s[20:21], v[36:37]
  s_cmp_eq_u64 vcc, -1
  s_cbranch_scc1 L_sequential_preLN__ssm_conv_h3__dense_activation_silu__prompt_kernel_42
  s_cmp_lt_u32 s22, 22
  s_cbranch_scc1 L_sequential_preLN__ssm_conv_h3__dense_activation_silu__prompt_kernel_47
L_sequential_preLN__ssm_conv_h3__dense_activation_silu__prompt_kernel_41:
  buffer_load_dwordx2 v[28:29], v25, s[24:27], s23 offen sc1
  s_add_u32 s22, s22, 1
  s_waitcnt vmcnt(0)
  v_cmp_eq_u64 vcc, s[20:21], v[28:29]
  s_or_b64 s[48:49], s[48:49], vcc
  s_cmp_eq_u64 s[48:49], -1
  s_cbranch_scc1 L_sequential_preLN__ssm_conv_h3__dense_activation_silu__prompt_kernel_42
  s_cmp_lt_u32 s22, 24
  s_cbranch_scc1 L_sequential_preLN__ssm_conv_h3__dense_activation_silu__prompt_kernel_41
  s_xor_b32 s23, s23, 0x8000
  s_xor_b32 s21, s21, s101
  s_cmp_lg_u32 s22, 24
  s_cbranch_scc1 L_sequential_preLN__ssm_conv_h3__dense_activation_silu__prompt_kernel_43
  s_mov_b32 s3, 0
L_sequential_preLN__ssm_conv_h3__dense_activation_silu__prompt_kernel_49:
  ds_read_b32 v38, v34 offset:28
  s_add_u32 s3, s3, 1
  s_waitcnt lgkmcnt(0)
  v_readfirstlane_b32 s50, v38
  s_cmp_ge_u32 s50, 4
  s_cbranch_scc1 L_sequential_preLN__ssm_conv_h3__dense_activation_silu__prompt_kernel_50
  s_cmp_lt_u32 s3, 2097152
  s_cbranch_scc1 L_sequential_preLN__ssm_conv_h3__dense_activation_silu__prompt_kernel_49
L_sequential_preLN__ssm_conv_h3__dense_activation_silu__prompt_kernel_50:
  buffer_wbl2 sc1
  s_waitcnt vmcnt(0)
  v_mov_b32 v28, s96
  v_mov_b32 v29, s97
  v_lshlrev_b32 v38, 8, v2
  s_mov_b64 exec, 15
  buffer_store_dwordx2 v[28:29], v38, s[24:27], s74 offen sc1
  s_mov_b64 exec, -1
  s_waitcnt vmcnt(0)
L_sequential_preLN__ssm_conv_h3__dense_activation_silu__prompt_kernel_43:
  s_cmp_lt_u32 s22, 32768
  s_cbranch_scc1 L_sequential_preLN__ssm_conv_h3__dense_activation_silu__prompt_kernel_41
L_sequential_preLN__ssm_conv_h3__dense_activation_silu__prompt_kernel_42:
  s_mov_b64 exec, 1
  ds_add_u32 v34, v39 offset:16
  s_mov_b64 exec, -1
  s_branch L_sequential_preLN__ssm_conv_h3__dense_activation_silu__prompt_kernel_45
L_sequential_preLN__ssm_conv_h3__dense_activation_silu__prompt_kernel_44:
  s_mov_b32 s3, 0
L_sequential_preLN__ssm_conv_h3__dense_activation_silu__prompt_kernel_51:
  ds_read_b32 v38, v34 offset:16
  s_add_u32 s3, s3, 1
  s_waitcnt lgkmcnt(0)
  v_readfirstlane_b32 s50, v38
  s_cmp_ge_u32 s50, 1
  s_cbranch_scc1 L_sequential_preLN__ssm_conv_h3__dense_activation_silu__prompt_kernel_52
  s_cmp_lt_u32 s3, 2097152
  s_cbranch_scc1 L_sequential_preLN__ssm_conv_h3__dense_activation_silu__prompt_kernel_51
L_sequential_preLN__ssm_conv_h3__dense_activation_silu__prompt_kernel_52:
L_sequential_preLN__ssm_conv_h3__dense_activation_silu__prompt_kernel_45:
  s_mul_i32 s50, s40, 720896
  s_lshl_b32 s51, s41, 13
  s_add_u32 s50, s50, s51
  s_add_u32 s50, s50, 262144
  s_add_u32 s51, s50, 4096
  buffer_load_dwordx4 v[64:67], v7, s[24:27], s50 offen sc1
  buffer_load_dwordx4 v[68:71], v7, s[24:27], s51 offen sc1
  s_mov_b32 s3, 0
L_sequential_preLN__ssm_conv_h3__dense_activation_silu__prompt_kernel_53:
  buffer_load_dwordx4 v[120:123], v24, s[24:27], s77 offen offset:0 sc1
  buffer_load_dwordx4 v[124:127], v24, s[24:27], s77 offen offset:1024 sc1
  buffer_load_dwordx4 v[128:131], v24, s[24:27], s77 offen offset:2048 sc1
  buffer_load_dwordx4 v[132:135], v24, s[24:27], s77 offen offset:3072 sc1
  s_mov_b64 s[48:49], -1
  s_add_u32 s3, s3, 1
  s_waitcnt vmcnt(0)
  v_perm_b32 v136, v121, v120, s4
  v_perm_b32 v137, v123, v122, s5
  v_or_b32 v136, v136, v137
  v_cmp_eq_u32 vcc, s96, v136
  s_and_b64 s[48:49], s[48:49], vcc
  v_perm_b32 v136, v125, v124, s4
  v_perm_b32 v137, v127, v126, s5
  v_or_b32 v136, v136, v137
  v_cmp_eq_u32 vcc, s96, v136
  s_and_b64 s[48:49], s[48:49], vcc
  v_perm_b32 v136, v129, v128, s4
  v_perm_b32 v137, v131, v130, s5
  v_or_b32 v136, v136, v137
  v_cmp_eq_u32 vcc, s96, v136
  s_and_b64 s[48:49], s[48:49], vcc
  v_perm_b32 v136, v133, v132, s4
  v_perm_b32 v137, v135, v134, s5
  v_or_b32 v136, v136, v137
  v_cmp_eq_u32 vcc, s96, v136
  s_and_b64 s[48:49], s[48:49], vcc
  s_cmp_eq_u64 s[48:49], -1
  s_cbranch_scc1 L_sequential_preLN__ssm_conv_h3__dense_activation_silu__prompt_kernel_54
  s_cmp_lt_u32 s3, 32768
  s_cbranch_scc1 L_sequential_preLN__ssm_conv_h3__dense_activation_silu__prompt_kernel_53
L_sequential_preLN__ssm_conv_h3__dense_activation_silu__prompt_kernel_54:
  ds_write_b128 v12, v[120:123] offset:0
  ds_write_b128 v12, v[124:127] offset:1024
  ds_write_b128 v12, v[128:131] offset:2048
  ds_write_b128 v12, v[132:135] offset:3072
  s_lshl_b32 s46, s100, 5
  s_mul_i32 s47, s43, 22016
  s_add_u32 s46, s46, s47
  s_mul_i32 s47, s43, 2816
  s_add_u32 s47, s47, 65536
  s_mov_b32 s3, 0
L_sequential_preLN__ssm_conv_h3__dense_activation_silu__prompt_kernel_55:
  ds_read_b32 v38, v34 offset:4
  s_add_u32 s3, s3, 1
  s_waitcnt lgkmcnt(0)
  v_readfirstlane_b32 s50, v38
  s_cmp_ge_u32 s50, 8
  s_cbranch_scc1 L_sequential_preLN__ssm_conv_h3__dense_activation_silu__prompt_kernel_56
  s_cmp_lt_u32 s3, 2097152
  s_cbranch_scc1 L_sequential_preLN__ssm_conv_h3__dense_activation_silu__prompt_kernel_55
L_sequential_preLN__ssm_conv_h3__dense_activation_silu__prompt_kernel_56:
  s_add_u32 m0, s47, 0
  s_add_u32 s51, s46, 0
  buffer_load_dwordx4 v20, s[8:11], s51 offen lds
  buffer_load_dwordx4 v21, s[8:11], s51 offen offset:1024 lds
  s_mov_b32 exec_hi, 0xffff
  buffer_load_dwordx4 v22, s[8:11], s51 offen offset:2048 lds
  s_mov_b32 exec_hi, -1
  s_add_u32 m0, s47, 11264
  s_add_u32 s51, s46, 88064
  buffer_load_dwordx4 v20, s[8:11], s51 offen lds
  buffer_load_dwordx4 v21, s[8:11], s51 offen offset:1024 lds
  s_mov_b32 exec_hi, 0xffff
  buffer_load_dwordx4 v22, s[8:11], s51 offen offset:2048 lds
  s_mov_b32 exec_hi, -1
  v_sub_u32 v16, 25296, v7
  ds_read_b128 v[72:75], v16
  ds_read_b128 v[76:79], v16 offset:25792
  ds_read_b128 v[80:83], v13 offset:0
  ds_read_b128 v[84:87], v13 offset:16
  ds_read_b128 v[88:91], v13 offset:32
  ds_read_b128 v[92:95], v13 offset:48
  s_lshl_b32 s50, s55, 16
  s_and_b32 s51, s55, 0xffff0000
  v_lshlrev_b32 v152, 16, v64
  v_and_b32 v153, s79, v64
  v_lshlrev_b32 v154, 16, v65
  v_and_b32 v155, s79, v65
  v_lshlrev_b32 v156, 16, v66
  v_and_b32 v157, s79, v66
  v_lshlrev_b32 v158, 16, v67
  v_and_b32 v159, s79, v67
  v_lshlrev_b32 v160, 16, v68
  v_and_b32 v161, s79, v68
  v_lshlrev_b32 v162, 16, v69
  v_and_b32 v163, s79, v69
  v_lshlrev_b32 v164, 16, v70
  v_and_b32 v165, s79, v70
  v_lshlrev_b32 v166, 16, v71
  v_and_b32 v167, s79, v71
  s_waitcnt lgkmcnt(0)
  s_mov_b64 exec, 1
  ds_add_u32 v35, v39 offset:28
  s_mov_b64 exec, -1
  s_add_u32 m0, s47, 22528
  s_add_u32 s51, s46, 176128
  buffer_load_dwordx4 v20, s[8:11], s51 offen lds
  buffer_load_dwordx4 v21, s[8:11], s51 offen offset:1024 lds
  s_mov_b32 exec_hi, 0xffff
  buffer_load_dwordx4 v22, s[8:11], s51 offen offset:2048 lds
  s_mov_b32 exec_hi, -1
  s_add_u32 m0, s47, 33792
  s_add_u32 s51, s46, 264192
  buffer_load_dwordx4 v20, s[8:11], s51 offen lds
  buffer_load_dwordx4 v21, s[8:11], s51 offen offset:1024 lds
  s_mov_b32 exec_hi, 0xffff
  buffer_load_dwordx4 v22, s[8:11], s51 offen offset:2048 lds
  s_mov_b32 exec_hi, -1
  s_lshl_b32 s50, s55, 16
  s_and_b32 s51, s55, 0xffff0000
  v_and_b32 v168, s79, v75
  v_lshlrev_b32 v169, 16, v75
  v_and_b32 v170, s79, v74
  v_lshlrev_b32 v171, 16, v74
  v_and_b32 v172, s79, v73
  v_lshlrev_b32 v173, 16, v73
  v_and_b32 v174, s79, v72
  v_lshlrev_b32 v175, 16, v72
  v_mul_f32 v168, s50, v168
  v_mul_f32 v169, s50, v169
  v_mul_f32 v170, s50, v170
  v_mul_f32 v171, s50, v171
  v_mul_f32 v172, s50, v172
  v_mul_f32 v173, s50, v173
  v_mul_f32 v174, s50, v174
  v_mul_f32 v175, s50, v175
  v_and_b32 v176, s79, v79
  v_lshlrev_b32 v177, 16, v79
  v_and_b32 v178, s79, v78
  v_lshlrev_b32 v179, 16, v78
  v_and_b32 v180, s79, v77
  v_lshlrev_b32 v181, 16, v77
  v_and_b32 v182, s79, v76
  v_lshlrev_b32 v183, 16, v76
  v_mul_f32 v176, s51, v176
  v_mul_f32 v177, s51, v177
  v_mul_f32 v178, s51, v178
  v_mul_f32 v179, s51, v179
  v_mul_f32 v180, s51, v180
  v_mul_f32 v181, s51, v181
  v_mul_f32 v182, s51, v182
  v_mul_f32 v183, s51, v183
  v_and_b32 v80, s6, v80
  v_and_b32 v81, s6, v81
  v_and_b32 v82, s6, v82
  v_and_b32 v83, s6, v83
  v_and_b32 v84, s6, v84
  v_and_b32 v85, s6, v85
  v_and_b32 v86, s6, v86
  v_and_b32 v87, s6, v87
  v_and_b32 v88, s6, v88
  v_and_b32 v89, s6, v89
  v_and_b32 v90, s6, v90
  v_and_b32 v91, s6, v91
  v_and_b32 v92, s6, v92
  v_and_b32 v93, s6, v93
  v_and_b32 v94, s6, v94
  v_and_b32 v95, s6, v95
  v_fma_f32 v184, v152, v80, v81
  v_fma_f32 v185, v153, v82, v83
  v_fma_f32 v186, v154, v84, v85
  v_fma_f32 v187, v155, v86, v87
  v_fma_f32 v188, v156, v88, v89
  v_fma_f32 v189, v157, v90, v91
  v_fma_f32 v190, v158, v92, v93
  v_fma_f32 v191, v159, v94, v95
  v_fmac_f32 v152, v184, v168
  v_fmac_f32 v153, v185, v169
  v_fmac_f32 v154, v186, v170
  v_fmac_f32 v155, v187, v171
  v_fmac_f32 v156, v188, v172
  v_fmac_f32 v157, v189, v173
  v_fmac_f32 v158, v190, v174
  v_fmac_f32 v159, v191, v175
  v_fma_f32 v192, v160, v80, v81
  v_fma_f32 v193, v161, v82, v83
  v_fma_f32 v194, v162, v84, v85
  v_fma_f32 v195, v163, v86, v87
  v_fma_f32 v196, v164, v88, v89
  v_fma_f32 v197, v165, v90, v91
  v_fma_f32 v198, v166, v92, v93
  v_fma_f32 v199, v167, v94, v95
  v_fmac_f32 v160, v192, v176
  v_fmac_f32 v161, v193, v177
  v_fmac_f32 v162, v194, v178
  v_fmac_f32 v163, v195, v179
  v_fmac_f32 v164, v196, v180
  v_fmac_f32 v165, v197, v181
  v_fmac_f32 v166, v198, v182
  v_fmac_f32 v167, v199, v183
  s_mov_b32 s3, 0
L_sequential_preLN__ssm_conv_h3__dense_activation_silu__prompt_kernel_57:
  ds_read_b32 v38, v35 offset:28
  s_add_u32 s3, s3, 1
  s_waitcnt lgkmcnt(0)
  v_readfirstlane_b32 s50, v38
  s_cmp_ge_u32 s50, 4
  s_cbranch_scc1 L_sequential_preLN__ssm_conv_h3__dense_activation_silu__prompt_kernel_58
  s_cmp_lt_u32 s3, 2097152
  s_cbranch_scc1 L_sequential_preLN__ssm_conv_h3__dense_activation_silu__prompt_kernel_57
L_sequential_preLN__ssm_conv_h3__dense_activation_silu__prompt_kernel_58:
  s_add_u32 m0, s47, 45056
  s_add_u32 s51, s46, 352256
  buffer_load_dwordx4 v20, s[8:11], s51 offen lds
  buffer_load_dwordx4 v21, s[8:11], s51 offen offset:1024 lds
  s_mov_b32 exec_hi, 0xffff
  buffer_load_dwordx4 v22, s[8:11], s51 offen offset:2048 lds
  s_mov_b32 exec_hi, -1
  s_add_u32 m0, s47, 56320
  s_add_u32 s51, s46, 440320
  buffer_load_dwordx4 v20, s[8:11], s51 offen lds
  buffer_load_dwordx4 v21, s[8:11], s51 offen offset:1024 lds
  s_mov_b32 exec_hi, 0xffff
  buffer_load_dwordx4 v22, s[8:11], s51 offen offset:2048 lds
  s_mov_b32 exec_hi, -1
  v_bfe_u32 v17, v6, 2, 2
  v_xor_b32 v17, v6, v17
  v_lshlrev_b32 v17, 5, v17
  v_add_u32 v16, 53248, v17
  v_add_u32 v17, 133120, v17
  v_lshrrev_b32 v18, 3, v6
  v_lshlrev_b32 v18, 16, v18
  v_and_b32 v19, 7, v6
  v_lshl_add_u32 v18, v19, 4, v18
  s_lshl_b32 s50, s58, 7
  s_add_u32 s50, s50, 7340032
  s_barrier
  ds_read_b128 v[200:203], v17 offset:0
  ds_read_b128 v[204:207], v17 offset:16
  ds_read_b128 v[208:211], v17 offset:8192
  ds_read_b128 v[212:215], v17 offset:8208
  ds_read_b128 v[216:219], v17 offset:16384
  ds_read_b128 v[220:223], v17 offset:16400
  ds_read_b128 v[224:227], v16 offset:0
  ds_read_b128 v[228:231], v16 offset:16
  s_waitcnt lgkmcnt(4)
  v_pk_add_f32 v[200:201], v[200:201], v[208:209]
  v_pk_add_f32 v[202:203], v[202:203], v[210:211]
  v_pk_add_f32 v[204:205], v[204:205], v[212:213]
  v_pk_add_f32 v[206:207], v[206:207], v[214:215]
  v_pk_fma_f32 v[152:153], v[184:185], v[200:201], v[152:153]
  v_pk_fma_f32 v[154:155], v[186:187], v[202:203], v[154:155]
  v_pk_fma_f32 v[156:157], v[188:189], v[204:205], v[156:157]
  v_pk_fma_f32 v[158:159], v[190:191], v[206:207], v[158:159]
  v_cvt_pk_bf16_f32 v64, v152, v153
  v_cvt_pk_bf16_f32 v65, v154, v155
  v_cvt_pk_bf16_f32 v66, v156, v157
  v_cvt_pk_bf16_f32 v67, v158, v159
  buffer_store_dwordx4 v[64:67], v18, s[24:27], s50 offen offset:0 sc1
  s_waitcnt lgkmcnt(0)
  v_pk_add_f32 v[216:217], v[216:217], v[224:225]
  v_pk_add_f32 v[218:219], v[218:219], v[226:227]
  v_pk_add_f32 v[220:221], v[220:221], v[228:229]
  v_pk_add_f32 v[222:223], v[222:223], v[230:231]
  v_pk_fma_f32 v[160:161], v[192:193], v[216:217], v[160:161]
  v_pk_fma_f32 v[162:163], v[194:195], v[218:219], v[162:163]
  v_pk_fma_f32 v[164:165], v[196:197], v[220:221], v[164:165]
  v_pk_fma_f32 v[166:167], v[198:199], v[222:223], v[166:167]
  v_cvt_pk_bf16_f32 v68, v160, v161
  v_cvt_pk_bf16_f32 v69, v162, v163
  v_cvt_pk_bf16_f32 v70, v164, v165
  v_cvt_pk_bf16_f32 v71, v166, v167
  buffer_store_dwordx4 v[68:71], v18, s[24:27], s50 offen offset:128 sc1
  s_waitcnt vmcnt(2)
  s_barrier
  s_waitcnt vmcnt(0)
  s_mov_b64 exec, 1
  ds_add_rtn_u32 v38, v34, v39 offset:20
  s_mov_b64 exec, 0xff
  v_lshlrev_b32 v16, 10, v2
  v_mov_b32 v17, s96
  s_lshl_b32 s50, s2, 2
  s_add_u32 s50, s50, 6750208
  s_waitcnt lgkmcnt(0)
  v_readfirstlane_b32 s3, v38
  s_cmp_lg_u32 s3, 3
  s_cbranch_scc1 L_sequential_preLN__ssm_conv_h3__dense_activation_silu__prompt_kernel_59
  buffer_store_dword v17, v16, s[24:27], s50 offen sc1
L_sequential_preLN__ssm_conv_h3__dense_activation_silu__prompt_kernel_59:
  s_mov_b64 exec, -1
  v_and_b32 v5, 6, v3
  v_xor_b32 v5, v4, v5
  v_lshlrev_b32 v3, 7, v3
  v_lshl_add_u32 v3, v5, 4, v3
  s_lshl_b32 s49, s42, 10
  s_lshl_b32 s48, s98, 16
  s_add_u32 s48, s48, s49
  s_add_u32 s48, s48, 7340032
  s_lshl_b32 s72, s43, 13
  s_lshl_b32 s54, s99, 7
  s_add_u32 s72, s72, s54
  s_lshl_b32 s73, s43, 10
  v_lshl_add_u32 v32, v8, 3, v9
  v_lshlrev_b32 v32, 7, v32
  v_lshl_add_u32 v32, v10, 3, v32
  v_lshrrev_b32 v33, 1, v9
  v_lshl_or_b32 v33, v11, 1, v33
  v_lshl_add_u32 v32, v33, 5, v32
  s_lshl_b32 s54, s56, 12
  v_add_u32 v32, s54, v32
  v_xor_b32 v33, 32, v32
  v_xor_b32 v34, 64, v32
  v_xor_b32 v35, 96, v32
  v_add_u32 v36, 0x10000, v32
  v_add_u32 v40, 0x20000, v32
  v_add_u32 v37, 0x10000, v33
  v_add_u32 v41, 0x20000, v33
  v_add_u32 v38, 0x10000, v34
  v_add_u32 v42, 0x20000, v34
  v_add_u32 v39, 0x10000, v35
  v_add_u32 v43, 0x20000, v35
  v_lshl_add_u32 v5, v8, 2, v9
  v_bfe_u32 v16, v5, 1, 2
  v_xor_b32 v16, s43, v16
  v_lshlrev_b32 v17, 7, v5
  v_lshl_add_u32 v17, v10, 3, v17
  v_lshl_add_u32 v16, v16, 5, v17
  s_lshl_b32 s54, s43, 8
  s_add_u32 s54, s54, 159744
  v_and_b32 v17, 15, v2
  v_lshlrev_b32 v17, 4, v17
  v_add_u32 v17, s54, v17
  s_lshl_b32 s54, s98, 9
  s_add_u32 s54, s54, 6815744
  v_lshlrev_b32 v18, 2, v2
  v_mov_b32 v248, 0x3f803f80
  v_mov_b32 v249, 0x3f803f80
  v_mov_b32 v250, 0x3f803f80
  v_mov_b32 v251, 0x3f803f80
  v_mov_b32 v6, 160768
  v_mov_b32 v7, 1
  s_add_u32 m0, s73, 155648
  s_add_u32 s51, s72, 1376256
  buffer_load_dwordx4 v23, s[12:15], s51 offen  lds
  buffer_load_dword v19, v18, s[24:27], s54 offen sc1
  s_cmp_lg_u32 s43, 0
  s_cbranch_scc1 L_sequential_preLN__ssm_conv_h3__dense_activation_silu__prompt_kernel_61
  s_mov_b32 s3, 0
L_sequential_preLN__ssm_conv_h3__dense_activation_silu__prompt_kernel_62:
  ds_read_b32 v5, v6 offset:16
  s_add_u32 s3, s3, 1
  s_waitcnt lgkmcnt(0)
  v_readfirstlane_b32 s50, v5
  s_cmp_ge_u32 s50, 16
  s_cbranch_scc1 L_sequential_preLN__ssm_conv_h3__dense_activation_silu__prompt_kernel_63
  s_cmp_lt_u32 s3, 2097152
  s_cbranch_scc1 L_sequential_preLN__ssm_conv_h3__dense_activation_silu__prompt_kernel_62
L_sequential_preLN__ssm_conv_h3__dense_activation_silu__prompt_kernel_63:
  s_lshl_b32 s62, s40, 10
  s_add_u32 s62, s62, 6750208
  s_mov_b32 s3, 0
  buffer_load_dwordx4 v[48:51], v24, s[24:27], s62 offen sc1
L_sequential_preLN__ssm_conv_h3__dense_activation_silu__prompt_kernel_60:
  buffer_load_dwordx4 v[52:55], v24, s[24:27], s62 offen sc1
  s_waitcnt vmcnt(1)
  v_xor_b32 v56, s96, v48
  v_xor_b32 v57, s96, v49
  v_xor_b32 v58, s96, v50
  v_xor_b32 v59, s96, v51
  v_or3_b32 v56, v56, v57, v58
  v_or_b32 v56, v56, v59
  v_cmp_eq_u32 vcc, 0, v56
  s_add_u32 s3, s3, 1
  s_cmp_eq_u64 vcc, -1
  s_cbranch_scc1 L_sequential_preLN__ssm_conv_h3__dense_activation_silu__prompt_kernel_61
  buffer_load_dwordx4 v[48:51], v24, s[24:27], s62 offen sc1
  s_waitcnt vmcnt(1)
  v_xor_b32 v56, s96, v52
  v_xor_b32 v57, s96, v53
  v_xor_b32 v58, s96, v54
  v_xor_b32 v59, s96, v55
  v_or3_b32 v56, v56, v57, v58
  v_or_b32 v56, v56, v59
  v_cmp_eq_u32 vcc, 0, v56
  s_add_u32 s3, s3, 1
  s_cmp_eq_u64 vcc, -1
  s_cbranch_scc1 L_sequential_preLN__ssm_conv_h3__dense_activation_silu__prompt_kernel_61
  s_cmp_lt_u32 s3, 32768
  s_cbranch_scc1 L_sequential_preLN__ssm_conv_h3__dense_activation_silu__prompt_kernel_60
L_sequential_preLN__ssm_conv_h3__dense_activation_silu__prompt_kernel_61:
  s_barrier
  s_add_u32 m0, s49, 32768
  s_add_u32 s51, s48, 32768
  buffer_load_dwordx4 v3, s[24:27], s51 offen sc1 lds
  s_add_u32 m0, s49, 40960
  s_add_u32 s51, s48, 40960
  buffer_load_dwordx4 v3, s[24:27], s51 offen sc1 lds
  s_add_u32 m0, s49, 49152
  s_add_u32 s51, s48, 49152
  buffer_load_dwordx4 v3, s[24:27], s51 offen sc1 lds
  s_add_u32 m0, s49, 57344
  s_add_u32 s51, s48, 57344
  buffer_load_dwordx4 v3, s[24:27], s51 offen sc1 lds
  s_add_u32 m0, s49, 0
  s_add_u32 s51, s48, 0
  buffer_load_dwordx4 v3, s[24:27], s51 offen sc1 lds
  s_add_u32 m0, s49, 8192
  s_add_u32 s51, s48, 8192
  buffer_load_dwordx4 v3, s[24:27], s51 offen sc1 lds
  s_add_u32 m0, s49, 16384
  s_add_u32 s51, s48, 16384
  buffer_load_dwordx4 v3, s[24:27], s51 offen sc1 lds
  s_add_u32 m0, s49, 24576
  s_add_u32 s51, s48, 24576
  buffer_load_dwordx4 v3, s[24:27], s51 offen sc1 lds
  s_lshl_b32 s3, s2, 3
  s_add_u32 s3, s3, s42
  s_cmp_lg_u32 s3, 7
  s_cbranch_scc1 L_nz
  v_mov_b32 v60, 0
  v_mov_b32 v61, 0
  s_mov_b64 exec, 1
  buffer_store_dwordx2 v[60:61], v60, s[68:71], 0 offen sc1
  s_mov_b64 exec, -1
L_nz:
  s_setprio 2
  s_waitcnt vmcnt(6)
  s_barrier
  ds_read_b64_tr_b16 v[224:225], v16 offset:32768
  ds_read_b64_tr_b16 v[226:227], v16 offset:34816
  ds_read_b64_tr_b16 v[228:229], v16 offset:36864
  ds_read_b64_tr_b16 v[230:231], v16 offset:38912
  ds_read_b64_tr_b16 v[232:233], v16 offset:40960
  ds_read_b64_tr_b16 v[234:235], v16 offset:43008
  ds_read_b64_tr_b16 v[236:237], v16 offset:45056
  ds_read_b64_tr_b16 v[238:239], v16 offset:47104
  s_waitcnt lgkmcnt(0)
  v_mfma_f32_16x16x32_bf16 v[240:243], v[224:227], v[224:227], 0
  v_mfma_f32_16x16x32_bf16 v[244:247], v[248:251], v[224:227], 0
  v_mfma_f32_16x16x32_bf16 v[240:243], v[228:231], v[228:231], v[240:243]
  v_mfma_f32_16x16x32_bf16 v[244:247], v[248:251], v[228:231], v[244:247]
  v_mfma_f32_16x16x32_bf16 v[240:243], v[232:235], v[232:235], v[240:243]
  v_mfma_f32_16x16x32_bf16 v[244:247], v[248:251], v[232:235], v[244:247]
  v_mfma_f32_16x16x32_bf16 v[240:243], v[236:239], v[236:239], v[240:243]
  v_mfma_f32_16x16x32_bf16 v[244:247], v[248:251], v[236:239], v[244:247]
  s_waitcnt vmcnt(4)
  s_barrier
  s_add_u32 m0, s73, 65536
  s_add_u32 s51, s72, 0
  buffer_load_dwordx4 v23, s[12:15], s51 offen  lds
  s_add_u32 m0, s73, 69632
  s_add_u32 s51, s72, 32768
  buffer_load_dwordx4 v23, s[12:15], s51 offen  lds
  s_add_u32 m0, s73, 73728
  s_add_u32 s51, s72, 131072
  buffer_load_dwordx4 v23, s[12:15], s51 offen  lds
  s_add_u32 m0, s73, 77824
  s_add_u32 s51, s72, 163840
  buffer_load_dwordx4 v23, s[12:15], s51 offen  lds
  ds_read_b64_tr_b16 v[224:225], v16 offset:49152
  ds_read_b64_tr_b16 v[226:227], v16 offset:51200
  ds_read_b64_tr_b16 v[228:229], v16 offset:53248
  ds_read_b64_tr_b16 v[230:231], v16 offset:55296
  ds_read_b64_tr_b16 v[232:233], v16 offset:57344
  ds_read_b64_tr_b16 v[234:235], v16 offset:59392
  ds_read_b64_tr_b16 v[236:237], v16 offset:61440
  ds_read_b64_tr_b16 v[238:239], v16 offset:63488
  s_waitcnt lgkmcnt(0)
  v_mfma_f32_16x16x32_bf16 v[240:243], v[224:227], v[224:227], v[240:243]
  v_mfma_f32_16x16x32_bf16 v[244:247], v[248:251], v[224:227], v[244:247]
  v_mfma_f32_16x16x32_bf16 v[240:243], v[228:231], v[228:231], v[240:243]
  v_mfma_f32_16x16x32_bf16 v[244:247], v[248:251], v[228:231], v[244:247]
  v_mfma_f32_16x16x32_bf16 v[240:243], v[232:235], v[232:235], v[240:243]
  v_mfma_f32_16x16x32_bf16 v[244:247], v[248:251], v[232:235], v[244:247]
  v_mfma_f32_16x16x32_bf16 v[240:243], v[236:239], v[236:239], v[240:243]
  v_mfma_f32_16x16x32_bf16 v[244:247], v[248:251], v[236:239], v[244:247]
  s_waitcnt vmcnt(6)
  s_barrier
  s_add_u32 m0, s73, 81920
  s_add_u32 s51, s72, 262144
  buffer_load_dwordx4 v23, s[12:15], s51 offen  lds
  s_add_u32 m0, s73, 86016
  s_add_u32 s51, s72, 294912
  buffer_load_dwordx4 v23, s[12:15], s51 offen  lds
  s_add_u32 m0, s73, 90112
  s_add_u32 s51, s72, 393216
  buffer_load_dwordx4 v23, s[12:15], s51 offen  lds
  s_add_u32 m0, s73, 94208
  s_add_u32 s51, s72, 425984
  buffer_load_dwordx4 v23, s[12:15], s51 offen  lds
  s_add_u32 m0, s73, 98304
  s_add_u32 s51, s72, 524288
  buffer_load_dwordx4 v23, s[12:15], s51 offen  lds
  s_add_u32 m0, s73, 102400
  s_add_u32 s51, s72, 557056
  buffer_load_dwordx4 v23, s[12:15], s51 offen  lds
  ds_read_b64_tr_b16 v[224:225], v16 offset:0
  ds_read_b64_tr_b16 v[226:227], v16 offset:2048
  ds_read_b64_tr_b16 v[228:229], v16 offset:4096
  ds_read_b64_tr_b16 v[230:231], v16 offset:6144
  ds_read_b64_tr_b16 v[232:233], v16 offset:8192
  ds_read_b64_tr_b16 v[234:235], v16 offset:10240
  ds_read_b64_tr_b16 v[236:237], v16 offset:12288
  ds_read_b64_tr_b16 v[238:239], v16 offset:14336
  s_waitcnt lgkmcnt(0)
  v_mfma_f32_16x16x32_bf16 v[240:243], v[224:227], v[224:227], v[240:243]
  v_mfma_f32_16x16x32_bf16 v[244:247], v[248:251], v[224:227], v[244:247]
  v_mfma_f32_16x16x32_bf16 v[240:243], v[228:231], v[228:231], v[240:243]
  v_mfma_f32_16x16x32_bf16 v[244:247], v[248:251], v[228:231], v[244:247]
  v_mfma_f32_16x16x32_bf16 v[240:243], v[232:235], v[232:235], v[240:243]
  v_mfma_f32_16x16x32_bf16 v[244:247], v[248:251], v[232:235], v[244:247]
  v_mfma_f32_16x16x32_bf16 v[240:243], v[236:239], v[236:239], v[240:243]
  v_mfma_f32_16x16x32_bf16 v[244:247], v[248:251], v[236:239], v[244:247]
  s_waitcnt vmcnt(10)
  s_barrier
  s_add_u32 m0, s73, 106496
  s_add_u32 s51, s72, 655360
  buffer_load_dwordx4 v23, s[12:15], s51 offen  lds
  s_add_u32 m0, s73, 110592
  s_add_u32 s51, s72, 688128
  buffer_load_dwordx4 v23, s[12:15], s51 offen  lds
  s_add_u32 m0, s73, 114688
  s_add_u32 s51, s72, 786432
  buffer_load_dwordx4 v23, s[12:15], s51 offen  lds
  s_add_u32 m0, s73, 118784
  s_add_u32 s51, s72, 819200
  buffer_load_dwordx4 v23, s[12:15], s51 offen  lds
  s_add_u32 m0, s73, 122880
  s_add_u32 s51, s72, 917504
  buffer_load_dwordx4 v23, s[12:15], s51 offen  lds
  s_add_u32 m0, s73, 126976
  s_add_u32 s51, s72, 950272
  buffer_load_dwordx4 v23, s[12:15], s51 offen  lds
  ds_read_b64_tr_b16 v[224:225], v16 offset:16384
  ds_read_b64_tr_b16 v[226:227], v16 offset:18432
  ds_read_b64_tr_b16 v[228:229], v16 offset:20480
  ds_read_b64_tr_b16 v[230:231], v16 offset:22528
  ds_read_b64_tr_b16 v[232:233], v16 offset:24576
  ds_read_b64_tr_b16 v[234:235], v16 offset:26624
  ds_read_b64_tr_b16 v[236:237], v16 offset:28672
  ds_read_b64_tr_b16 v[238:239], v16 offset:30720
  s_waitcnt lgkmcnt(0)
  v_mfma_f32_16x16x32_bf16 v[240:243], v[224:227], v[224:227], v[240:243]
  v_mfma_f32_16x16x32_bf16 v[244:247], v[248:251], v[224:227], v[244:247]
  v_mfma_f32_16x16x32_bf16 v[240:243], v[228:231], v[228:231], v[240:243]
  v_mfma_f32_16x16x32_bf16 v[244:247], v[248:251], v[228:231], v[244:247]
  v_mfma_f32_16x16x32_bf16 v[240:243], v[232:235], v[232:235], v[240:243]
  v_mfma_f32_16x16x32_bf16 v[244:247], v[248:251], v[232:235], v[244:247]
  v_mfma_f32_16x16x32_bf16 v[240:243], v[236:239], v[236:239], v[240:243]
  v_mfma_f32_16x16x32_bf16 v[244:247], v[248:251], v[236:239], v[244:247]
  s_nop 7
  v_cmp_eq_u32 vcc, 1, v10
  v_cmp_eq_u32 s[68:69], 2, v10
  v_cmp_eq_u32 s[70:71], 3, v10
  v_cndmask_b32 v240, v240, v241, vcc
  v_cndmask_b32 v240, v240, v242, s[68:69]
  v_cndmask_b32 v240, v240, v243, s[70:71]
  v_mul_f32 v244, 0xbb000000, v244
  v_mul_f32 v240, 0x3b000000, v240
  v_fma_f32 v240, -v244, v244, v240
  v_max_f32 v240, 0, v240
  v_add_f32 v240, 0x3727c5ac, v240
  v_rsq_f32 v240, v240
  v_cmp_eq_u32 vcc, v8, v9
  v_mul_f32 v241, 0xbfb8aa3b, v240
  v_mul_f32 v240, 0xbfb8aa3b, v240
  v_mul_f32 v242, v241, v244
  v_mul_f32 v243, v241, v244
  s_and_saveexec_b64 s[68:69], vcc
  ds_write_b128 v17, v[240:243]
  s_mov_b64 exec, 1
  ds_add_u32 v6, v7
  s_mov_b64 exec, -1
  s_setprio 0
  s_lshl_b32 s66, s57, 1
  s_add_u32 s66, s66, s56
  v_lshl_add_u32 v5, v8, 2, v9
  v_bfe_u32 v6, v5, 1, 2
  v_xor_b32 v6, s66, v6
  v_lshlrev_b32 v5, 7, v5
  v_lshl_add_u32 v5, v10, 3, v5
  v_lshl_add_u32 v5, v6, 5, v5
  s_lshl_b32 s54, s99, 13
  v_add_u32 v12, s54, v5
  ds_read_b64_tr_b16 v[14:15], v12 offset:6144
  ds_read_b64_tr_b16 v[12:13], v12 offset:4096
  v_mov_b32 v6, 160768
  s_waitcnt lgkmcnt(0)
  s_mov_b64 exec, 1
  ds_add_u32 v6, v7 offset:20
  s_mov_b64 exec, -1
  s_mov_b32 s3, 0
L_sequential_preLN__ssm_conv_h3__dense_activation_silu__prompt_kernel_64:
  ds_read_b32 v5, v6 offset:12
  s_add_u32 s3, s3, 1
  s_waitcnt lgkmcnt(0)
  v_readfirstlane_b32 s50, v5
  s_cmp_ge_u32 s50, 4
  s_cbranch_scc1 L_sequential_preLN__ssm_conv_h3__dense_activation_silu__prompt_kernel_65
  s_cmp_lt_u32 s3, 2097152
  s_cbranch_scc1 L_sequential_preLN__ssm_conv_h3__dense_activation_silu__prompt_kernel_64
L_sequential_preLN__ssm_conv_h3__dense_activation_silu__prompt_kernel_65:
  s_add_u32 m0, s73, 131072
  s_add_u32 s51, s72, 1048576
  buffer_load_dwordx4 v23, s[12:15], s51 offen  lds
  s_add_u32 m0, s73, 135168
  s_add_u32 s51, s72, 1081344
  buffer_load_dwordx4 v23, s[12:15], s51 offen  lds
  s_add_u32 m0, s73, 139264
  s_add_u32 s51, s72, 1179648
  buffer_load_dwordx4 v23, s[12:15], s51 offen  lds
  s_add_u32 m0, s73, 143360
  s_add_u32 s51, s72, 1212416
  buffer_load_dwordx4 v23, s[12:15], s51 offen  lds
  s_add_u32 m0, s73, 147456
  s_add_u32 s51, s72, 1310720
  buffer_load_dwordx4 v23, s[12:15], s51 offen  lds
  s_add_u32 m0, s73, 151552
  s_add_u32 s51, s72, 1343488
  buffer_load_dwordx4 v23, s[12:15], s51 offen  lds
  s_mov_b32 s3, 0
L_sequential_preLN__ssm_conv_h3__dense_activation_silu__prompt_kernel_66:
  ds_read_b32 v5, v6 offset:20
  s_add_u32 s3, s3, 1
  s_waitcnt lgkmcnt(0)
  v_readfirstlane_b32 s50, v5
  s_cmp_ge_u32 s50, 4
  s_cbranch_scc1 L_sequential_preLN__ssm_conv_h3__dense_activation_silu__prompt_kernel_67
  s_cmp_lt_u32 s3, 2097152
  s_cbranch_scc1 L_sequential_preLN__ssm_conv_h3__dense_activation_silu__prompt_kernel_66
L_sequential_preLN__ssm_conv_h3__dense_activation_silu__prompt_kernel_67:
  s_add_u32 m0, s73, 32768
  s_add_u32 s51, s72, 65536
  buffer_load_dwordx4 v23, s[12:15], s51 offen  lds
  s_add_u32 m0, s73, 36864
  s_add_u32 s51, s72, 98304
  buffer_load_dwordx4 v23, s[12:15], s51 offen  lds
  s_add_u32 m0, s73, 40960
  s_add_u32 s51, s72, 196608
  buffer_load_dwordx4 v23, s[12:15], s51 offen  lds
  s_add_u32 m0, s73, 45056
  s_add_u32 s51, s72, 229376
  buffer_load_dwordx4 v23, s[12:15], s51 offen  lds
  s_add_u32 m0, s73, 49152
  s_add_u32 s51, s72, 327680
  buffer_load_dwordx4 v23, s[12:15], s51 offen  lds
  s_add_u32 m0, s73, 53248
  s_add_u32 s51, s72, 360448
  buffer_load_dwordx4 v23, s[12:15], s51 offen  lds
  s_waitcnt vmcnt(18)
  s_mov_b64 exec, 1
  ds_add_u32 v6, v7 offset:4
  s_mov_b64 exec, -1
  s_mov_b32 s3, 0
L_sequential_preLN__ssm_conv_h3__dense_activation_silu__prompt_kernel_68:
  ds_read_b32 v5, v6 offset:4
  s_add_u32 s3, s3, 1
  s_waitcnt lgkmcnt(0)
  v_readfirstlane_b32 s50, v5
  s_cmp_ge_u32 s50, 4
  s_cbranch_scc1 L_sequential_preLN__ssm_conv_h3__dense_activation_silu__prompt_kernel_69
  s_cmp_lt_u32 s3, 2097152
  s_cbranch_scc1 L_sequential_preLN__ssm_conv_h3__dense_activation_silu__prompt_kernel_68
L_sequential_preLN__ssm_conv_h3__dense_activation_silu__prompt_kernel_69:
  ds_read_b64_tr_b16 v[48:49], v36 offset:0
  ds_read_b64_tr_b16 v[50:51], v36 offset:512
  ds_read_b64_tr_b16 v[52:53], v37 offset:0
  ds_read_b64_tr_b16 v[54:55], v37 offset:512
  ds_read_b64_tr_b16 v[56:57], v38 offset:0
  ds_read_b64_tr_b16 v[58:59], v38 offset:512
  ds_read_b64_tr_b16 v[60:61], v39 offset:0
  ds_read_b64_tr_b16 v[62:63], v39 offset:512
  ds_read_b64_tr_b16 v[64:65], v36 offset:8192
  ds_read_b64_tr_b16 v[66:67], v36 offset:8704
  ds_read_b64_tr_b16 v[68:69], v37 offset:8192
  ds_read_b64_tr_b16 v[70:71], v37 offset:8704
  ds_read_b64_tr_b16 v[72:73], v38 offset:8192
  ds_read_b64_tr_b16 v[74:75], v38 offset:8704
  ds_read_b64_tr_b16 v[76:77], v39 offset:8192
  ds_read_b64_tr_b16 v[78:79], v39 offset:8704
  ds_read_b64_tr_b16 v[80:81], v36 offset:16384
  ds_read_b64_tr_b16 v[82:83], v36 offset:16896
  ds_read_b64_tr_b16 v[84:85], v37 offset:16384
  ds_read_b64_tr_b16 v[86:87], v37 offset:16896
  ds_read_b64_tr_b16 v[88:89], v38 offset:16384
  ds_read_b64_tr_b16 v[90:91], v38 offset:16896
  ds_read_b64_tr_b16 v[92:93], v39 offset:16384
  ds_read_b64_tr_b16 v[94:95], v39 offset:16896
  ds_read_b64_tr_b16 v[96:97], v36 offset:24576
  ds_read_b64_tr_b16 v[98:99], v36 offset:25088
  ds_read_b64_tr_b16 v[100:101], v37 offset:24576
  ds_read_b64_tr_b16 v[102:103], v37 offset:25088
  ds_read_b64_tr_b16 v[104:105], v38 offset:24576
  ds_read_b64_tr_b16 v[106:107], v38 offset:25088
  ds_read_b64_tr_b16 v[108:109], v39 offset:24576
  ds_read_b64_tr_b16 v[110:111], v39 offset:25088
  ds_read_b64_tr_b16 v[112:113], v36 offset:32768
  ds_read_b64_tr_b16 v[114:115], v36 offset:33280
  ds_read_b64_tr_b16 v[116:117], v37 offset:32768
  ds_read_b64_tr_b16 v[118:119], v37 offset:33280
  ds_read_b64_tr_b16 v[120:121], v38 offset:32768
  ds_read_b64_tr_b16 v[122:123], v38 offset:33280
  ds_read_b64_tr_b16 v[124:125], v39 offset:32768
  ds_read_b64_tr_b16 v[126:127], v39 offset:33280
  s_waitcnt lgkmcnt(0)
  s_mov_b64 exec, 1
  ds_add_u32 v6, v7 offset:8
  s_mov_b64 exec, -1
  s_mov_b32 s3, 0
L_sequential_preLN__ssm_conv_h3__dense_activation_silu__prompt_kernel_70:
  ds_read_b32 v5, v6 offset:8
  s_add_u32 s3, s3, 1
  s_waitcnt lgkmcnt(0)
  v_readfirstlane_b32 s50, v5
  s_cmp_ge_u32 s50, 4
  s_cbranch_scc1 L_sequential_preLN__ssm_conv_h3__dense_activation_silu__prompt_kernel_71
  s_cmp_lt_u32 s3, 2097152
  s_cbranch_scc1 L_sequential_preLN__ssm_conv_h3__dense_activation_silu__prompt_kernel_70
L_sequential_preLN__ssm_conv_h3__dense_activation_silu__prompt_kernel_71:
  s_add_u32 m0, s73, 65536
  s_add_u32 s51, s72, 851968
  buffer_load_dwordx4 v23, s[12:15], s51 offen  lds
  s_add_u32 m0, s73, 69632
  s_add_u32 s51, s72, 884736
  buffer_load_dwordx4 v23, s[12:15], s51 offen  lds
  s_add_u32 m0, s73, 73728
  s_add_u32 s51, s72, 983040
  buffer_load_dwordx4 v23, s[12:15], s51 offen  lds
  s_add_u32 m0, s73, 77824
  s_add_u32 s51, s72, 1015808
  buffer_load_dwordx4 v23, s[12:15], s51 offen  lds
  s_add_u32 m0, s73, 81920
  s_add_u32 s51, s72, 1114112
  buffer_load_dwordx4 v23, s[12:15], s51 offen  lds
  s_add_u32 m0, s73, 86016
  s_add_u32 s51, s72, 1146880
  buffer_load_dwordx4 v23, s[12:15], s51 offen  lds
  s_add_u32 m0, s73, 90112
  s_add_u32 s51, s72, 1245184
  buffer_load_dwordx4 v23, s[12:15], s51 offen  lds
  s_add_u32 m0, s73, 94208
  s_add_u32 s51, s72, 1277952
  buffer_load_dwordx4 v23, s[12:15], s51 offen  lds
  s_mov_b32 s3, 0
L_sequential_preLN__ssm_conv_h3__dense_activation_silu__prompt_kernel_72:
  ds_read_b32 v5, v6 offset:24
  s_add_u32 s3, s3, 1
  s_waitcnt lgkmcnt(0)
  v_readfirstlane_b32 s50, v5
  s_cmp_ge_u32 s50, 4
  s_cbranch_scc1 L_sequential_preLN__ssm_conv_h3__dense_activation_silu__prompt_kernel_73
  s_cmp_lt_u32 s3, 2097152
  s_cbranch_scc1 L_sequential_preLN__ssm_conv_h3__dense_activation_silu__prompt_kernel_72
L_sequential_preLN__ssm_conv_h3__dense_activation_silu__prompt_kernel_73:
  s_add_u32 m0, s73, 57344
  s_add_u32 s51, s72, 458752
  buffer_load_dwordx4 v23, s[12:15], s51 offen  lds
  s_add_u32 m0, s73, 61440
  s_add_u32 s51, s72, 491520
  buffer_load_dwordx4 v23, s[12:15], s51 offen  lds
  s_add_u32 m0, s73, 0
  s_add_u32 s51, s72, 589824
  buffer_load_dwordx4 v23, s[12:15], s51 offen  lds
  s_add_u32 m0, s73, 4096
  s_add_u32 s51, s72, 622592
  buffer_load_dwordx4 v23, s[12:15], s51 offen  lds
  s_add_u32 m0, s73, 8192
  s_add_u32 s51, s72, 720896
  buffer_load_dwordx4 v23, s[12:15], s51 offen  lds
  s_add_u32 m0, s73, 12288
  s_add_u32 s51, s72, 753664
  buffer_load_dwordx4 v23, s[12:15], s51 offen  lds
  s_waitcnt vmcnt(20)
  s_mov_b64 exec, 1
  ds_add_u32 v6, v7 offset:4
  s_mov_b64 exec, -1
  s_mov_b32 s3, 0
L_sequential_preLN__ssm_conv_h3__dense_activation_silu__prompt_kernel_74:
  ds_read_b32 v5, v6 offset:4
  s_add_u32 s3, s3, 1
  s_waitcnt lgkmcnt(0)
  v_readfirstlane_b32 s50, v5
  s_cmp_ge_u32 s50, 8
  s_cbranch_scc1 L_sequential_preLN__ssm_conv_h3__dense_activation_silu__prompt_kernel_75
  s_cmp_lt_u32 s3, 2097152
  s_cbranch_scc1 L_sequential_preLN__ssm_conv_h3__dense_activation_silu__prompt_kernel_74
L_sequential_preLN__ssm_conv_h3__dense_activation_silu__prompt_kernel_75:
  ds_read_b64_tr_b16 v[128:129], v36 offset:40960
  ds_read_b64_tr_b16 v[130:131], v36 offset:41472
  ds_read_b64_tr_b16 v[132:133], v37 offset:40960
  ds_read_b64_tr_b16 v[134:135], v37 offset:41472
  ds_read_b64_tr_b16 v[136:137], v38 offset:40960
  ds_read_b64_tr_b16 v[138:139], v38 offset:41472
  ds_read_b64_tr_b16 v[140:141], v39 offset:40960
  ds_read_b64_tr_b16 v[142:143], v39 offset:41472
  ds_read_b64_tr_b16 v[144:145], v36 offset:49152
  ds_read_b64_tr_b16 v[146:147], v36 offset:49664
  ds_read_b64_tr_b16 v[148:149], v37 offset:49152
  ds_read_b64_tr_b16 v[150:151], v37 offset:49664
  ds_read_b64_tr_b16 v[152:153], v38 offset:49152
  ds_read_b64_tr_b16 v[154:155], v38 offset:49664
  ds_read_b64_tr_b16 v[156:157], v39 offset:49152
  ds_read_b64_tr_b16 v[158:159], v39 offset:49664
  ds_read_b64_tr_b16 v[160:161], v36 offset:57344
  ds_read_b64_tr_b16 v[162:163], v36 offset:57856
  ds_read_b64_tr_b16 v[164:165], v37 offset:57344
  ds_read_b64_tr_b16 v[166:167], v37 offset:57856
  ds_read_b64_tr_b16 v[168:169], v38 offset:57344
  ds_read_b64_tr_b16 v[170:171], v38 offset:57856
  ds_read_b64_tr_b16 v[172:173], v39 offset:57344
  ds_read_b64_tr_b16 v[174:175], v39 offset:57856
  ds_read_b64_tr_b16 v[176:177], v40 offset:0
  ds_read_b64_tr_b16 v[178:179], v40 offset:512
  ds_read_b64_tr_b16 v[180:181], v41 offset:0
  ds_read_b64_tr_b16 v[182:183], v41 offset:512
  ds_read_b64_tr_b16 v[184:185], v42 offset:0
  ds_read_b64_tr_b16 v[186:187], v42 offset:512
  ds_read_b64_tr_b16 v[188:189], v43 offset:0
  ds_read_b64_tr_b16 v[190:191], v43 offset:512
  ds_read_b64_tr_b16 v[192:193], v40 offset:8192
  ds_read_b64_tr_b16 v[194:195], v40 offset:8704
  ds_read_b64_tr_b16 v[196:197], v41 offset:8192
  ds_read_b64_tr_b16 v[198:199], v41 offset:8704
  ds_read_b64_tr_b16 v[200:201], v42 offset:8192
  ds_read_b64_tr_b16 v[202:203], v42 offset:8704
  ds_read_b64_tr_b16 v[204:205], v43 offset:8192
  ds_read_b64_tr_b16 v[206:207], v43 offset:8704
  ds_read_b64_tr_b16 v[208:209], v40 offset:16384
  ds_read_b64_tr_b16 v[210:211], v40 offset:16896
  ds_read_b64_tr_b16 v[212:213], v41 offset:16384
  ds_read_b64_tr_b16 v[214:215], v41 offset:16896
  ds_read_b64_tr_b16 v[216:217], v42 offset:16384
  ds_read_b64_tr_b16 v[218:219], v42 offset:16896
  ds_read_b64_tr_b16 v[220:221], v43 offset:16384
  ds_read_b64_tr_b16 v[222:223], v43 offset:16896
  s_waitcnt vmcnt(0)
  s_barrier
  s_lshl_b32 s52, s98, 9
  s_add_u32 s52, s52, 6815744
  v_and_b32 v5, 31, v2
  v_lshlrev_b32 v5, 3, v5
  v_lshlrev_b32 v1, 4, v2
  s_lshr_b32 s58, s41, 3
  s_lshl_b32 s58, s58, 2
  s_lshl_b32 s59, s57, 1
  s_add_u32 s58, s58, s59
  s_add_u32 s59, s58, 1
  s_sub_u32 s59, s59, s56
  s_add_u32 s58, s58, s56
  s_mul_i32 s58, s58, 43
  s_mul_i32 s59, s59, 43
  s_add_u32 s58, s58, s56
  s_add_u32 s59, s59, s56
  s_lshl_b32 s58, s58, 10
  s_lshl_b32 s59, s59, 10
  s_mul_i32 s54, s40, 720896
  s_add_u32 s58, s58, s54
  s_add_u32 s59, s59, s54
  s_cmp_lg_u32 s43, 0
  s_cbranch_scc1 L_sequential_preLN__ssm_conv_h3__dense_activation_silu__prompt_kernel_77
  s_mov_b32 s67, 0
  s_mov_b64 s[68:69], 0
  buffer_load_dwordx2 v[6:7], v5, s[24:27], s52 offen sc1
L_sequential_preLN__ssm_conv_h3__dense_activation_silu__prompt_kernel_79:
  buffer_load_dwordx2 v[44:45], v5, s[24:27], s52 offen sc1
  s_waitcnt vmcnt(1)
  v_cmp_eq_u64 vcc, s[44:45], v[6:7]
  s_add_u32 s67, s67, 1
  s_cmp_eq_u64 vcc, -1
  s_cbranch_scc1 L_sequential_preLN__ssm_conv_h3__dense_activation_silu__prompt_kernel_77
  buffer_load_dwordx2 v[6:7], v5, s[24:27], s52 offen sc1
  s_waitcnt vmcnt(1)
  v_cmp_eq_u64 vcc, s[44:45], v[44:45]
  s_cmp_eq_u64 vcc, -1
  s_cbranch_scc1 L_sequential_preLN__ssm_conv_h3__dense_activation_silu__prompt_kernel_77
  s_cmp_lt_u32 s67, 22
  s_cbranch_scc1 L_sequential_preLN__ssm_conv_h3__dense_activation_silu__prompt_kernel_79
L_sequential_preLN__ssm_conv_h3__dense_activation_silu__prompt_kernel_76:
  buffer_load_dwordx2 v[6:7], v5, s[24:27], s52 offen sc1
  s_add_u32 s67, s67, 1
  s_waitcnt vmcnt(0)
  v_cmp_eq_u64 vcc, s[44:45], v[6:7]
  s_or_b64 s[68:69], s[68:69], vcc
  s_cmp_eq_u64 s[68:69], -1
  s_cbranch_scc1 L_sequential_preLN__ssm_conv_h3__dense_activation_silu__prompt_kernel_77
  s_cmp_lt_u32 s67, 24
  s_cbranch_scc1 L_sequential_preLN__ssm_conv_h3__dense_activation_silu__prompt_kernel_76
  s_xor_b32 s52, s52, 256
  s_xor_b32 s45, s45, s101
  s_cmp_lg_u32 s67, 24
  s_cbranch_scc1 L_sequential_preLN__ssm_conv_h3__dense_activation_silu__prompt_kernel_78
  buffer_wbl2 sc1
  s_waitcnt vmcnt(0)
  v_mov_b32 v6, s96
  v_mov_b32 v7, s97
  s_lshl_b32 s70, s99, 5
  s_add_u32 s70, s70, s52
  s_mov_b64 exec, 15
  buffer_store_dwordx2 v[6:7], v5, s[24:27], s70 offen sc1
  s_mov_b64 exec, -1
  s_waitcnt vmcnt(0)
L_sequential_preLN__ssm_conv_h3__dense_activation_silu__prompt_kernel_78:
  s_cmp_lt_u32 s67, 32768
  s_cbranch_scc1 L_sequential_preLN__ssm_conv_h3__dense_activation_silu__prompt_kernel_76
L_sequential_preLN__ssm_conv_h3__dense_activation_silu__prompt_kernel_77:
  s_waitcnt lgkmcnt(0)
  s_barrier
  s_add_u32 s51, s58, 0
  buffer_load_dwordx4 v[16:19], v1, s[24:27], s51 offen sc1
  s_add_u32 s51, s59, 0
  buffer_load_dwordx4 v[20:23], v1, s[24:27], s51 offen sc1
  s_add_u32 s51, s58, 4096
  buffer_load_dwordx4 v[24:27], v1, s[24:27], s51 offen sc1
  s_add_u32 s51, s59, 4096
  buffer_load_dwordx4 v[28:31], v1, s[24:27], s51 offen sc1
  s_add_u32 s51, s58, 8192
  buffer_load_dwordx4 v[32:35], v1, s[24:27], s51 offen sc1
  s_add_u32 s51, s59, 8192
  buffer_load_dwordx4 v[36:39], v1, s[24:27], s51 offen sc1
  s_add_u32 s51, s58, 12288
  buffer_load_dwordx4 v[40:43], v1, s[24:27], s51 offen sc1
  s_add_u32 s51, s59, 12288
  buffer_load_dwordx4 v[44:47], v1, s[24:27], s51 offen sc1
  s_waitcnt vmcnt(7)
  v_mfma_f32_16x16x32_bf16 v[224:227], v[48:51], v[16:19], 0
  v_mfma_f32_16x16x32_bf16 v[228:231], v[52:55], v[16:19], 0
  v_mfma_f32_16x16x32_bf16 v[232:235], v[56:59], v[16:19], 0
  v_mfma_f32_16x16x32_bf16 v[236:239], v[60:63], v[16:19], 0
  s_waitcnt vmcnt(6)
  v_mfma_f32_16x16x32_bf16 v[240:243], v[48:51], v[20:23], 0
  v_mfma_f32_16x16x32_bf16 v[244:247], v[52:55], v[20:23], 0
  v_mfma_f32_16x16x32_bf16 v[248:251], v[56:59], v[20:23], 0
  v_mfma_f32_16x16x32_bf16 v[252:255], v[60:63], v[20:23], 0
  s_add_u32 s51, s58, 16384
  buffer_load_dwordx4 v[16:19], v1, s[24:27], s51 offen sc1
  s_add_u32 s51, s59, 16384
  buffer_load_dwordx4 v[20:23], v1, s[24:27], s51 offen sc1
  s_waitcnt vmcnt(7)
  v_mfma_f32_16x16x32_bf16 v[224:227], v[64:67], v[24:27], v[224:227]
  v_mfma_f32_16x16x32_bf16 v[228:231], v[68:71], v[24:27], v[228:231]
  v_mfma_f32_16x16x32_bf16 v[232:235], v[72:75], v[24:27], v[232:235]
  v_mfma_f32_16x16x32_bf16 v[236:239], v[76:79], v[24:27], v[236:239]
  s_waitcnt vmcnt(6)
  v_mfma_f32_16x16x32_bf16 v[240:243], v[64:67], v[28:31], v[240:243]
  v_mfma_f32_16x16x32_bf16 v[244:247], v[68:71], v[28:31], v[244:247]
  v_mfma_f32_16x16x32_bf16 v[248:251], v[72:75], v[28:31], v[248:251]
  v_mfma_f32_16x16x32_bf16 v[252:255], v[76:79], v[28:31], v[252:255]
  s_add_u32 s51, s58, 20480
  buffer_load_dwordx4 v[24:27], v1, s[24:27], s51 offen sc1
  s_add_u32 s51, s59, 20480
  buffer_load_dwordx4 v[28:31], v1, s[24:27], s51 offen sc1
  s_waitcnt vmcnt(7)
  v_mfma_f32_16x16x32_bf16 v[224:227], v[80:83], v[32:35], v[224:227]
  v_mfma_f32_16x16x32_bf16 v[228:231], v[84:87], v[32:35], v[228:231]
  v_mfma_f32_16x16x32_bf16 v[232:235], v[88:91], v[32:35], v[232:235]
  v_mfma_f32_16x16x32_bf16 v[236:239], v[92:95], v[32:35], v[236:239]
  s_waitcnt vmcnt(6)
  v_mfma_f32_16x16x32_bf16 v[240:243], v[80:83], v[36:39], v[240:243]
  v_mfma_f32_16x16x32_bf16 v[244:247], v[84:87], v[36:39], v[244:247]
  v_mfma_f32_16x16x32_bf16 v[248:251], v[88:91], v[36:39], v[248:251]
  v_mfma_f32_16x16x32_bf16 v[252:255], v[92:95], v[36:39], v[252:255]
  s_add_u32 s51, s58, 24576
  buffer_load_dwordx4 v[32:35], v1, s[24:27], s51 offen sc1
  s_add_u32 s51, s59, 24576
  buffer_load_dwordx4 v[36:39], v1, s[24:27], s51 offen sc1
  s_waitcnt vmcnt(7)
  v_mfma_f32_16x16x32_bf16 v[224:227], v[96:99], v[40:43], v[224:227]
  v_mfma_f32_16x16x32_bf16 v[228:231], v[100:103], v[40:43], v[228:231]
  v_mfma_f32_16x16x32_bf16 v[232:235], v[104:107], v[40:43], v[232:235]
  v_mfma_f32_16x16x32_bf16 v[236:239], v[108:111], v[40:43], v[236:239]
  s_waitcnt vmcnt(6)
  v_mfma_f32_16x16x32_bf16 v[240:243], v[96:99], v[44:47], v[240:243]
  v_mfma_f32_16x16x32_bf16 v[244:247], v[100:103], v[44:47], v[244:247]
  v_mfma_f32_16x16x32_bf16 v[248:251], v[104:107], v[44:47], v[248:251]
  v_mfma_f32_16x16x32_bf16 v[252:255], v[108:111], v[44:47], v[252:255]
  s_add_u32 s51, s58, 28672
  buffer_load_dwordx4 v[40:43], v1, s[24:27], s51 offen sc1
  s_add_u32 s51, s59, 28672
  buffer_load_dwordx4 v[44:47], v1, s[24:27], s51 offen sc1
  s_waitcnt vmcnt(7)
  v_mfma_f32_16x16x32_bf16 v[224:227], v[112:115], v[16:19], v[224:227]
  v_mfma_f32_16x16x32_bf16 v[228:231], v[116:119], v[16:19], v[228:231]
  v_mfma_f32_16x16x32_bf16 v[232:235], v[120:123], v[16:19], v[232:235]
  v_mfma_f32_16x16x32_bf16 v[236:239], v[124:127], v[16:19], v[236:239]
  s_waitcnt vmcnt(6)
  v_mfma_f32_16x16x32_bf16 v[240:243], v[112:115], v[20:23], v[240:243]
  v_mfma_f32_16x16x32_bf16 v[244:247], v[116:119], v[20:23], v[244:247]
  v_mfma_f32_16x16x32_bf16 v[248:251], v[120:123], v[20:23], v[248:251]
  v_mfma_f32_16x16x32_bf16 v[252:255], v[124:127], v[20:23], v[252:255]
  s_add_u32 s51, s58, 32768
  buffer_load_dwordx4 v[16:19], v1, s[24:27], s51 offen sc1
  s_add_u32 s51, s59, 32768
  buffer_load_dwordx4 v[20:23], v1, s[24:27], s51 offen sc1
  s_waitcnt vmcnt(7)
  v_mfma_f32_16x16x32_bf16 v[224:227], v[128:131], v[24:27], v[224:227]
  v_mfma_f32_16x16x32_bf16 v[228:231], v[132:135], v[24:27], v[228:231]
  v_mfma_f32_16x16x32_bf16 v[232:235], v[136:139], v[24:27], v[232:235]
  v_mfma_f32_16x16x32_bf16 v[236:239], v[140:143], v[24:27], v[236:239]
  s_waitcnt vmcnt(6)
  v_mfma_f32_16x16x32_bf16 v[240:243], v[128:131], v[28:31], v[240:243]
  v_mfma_f32_16x16x32_bf16 v[244:247], v[132:135], v[28:31], v[244:247]
  v_mfma_f32_16x16x32_bf16 v[248:251], v[136:139], v[28:31], v[248:251]
  v_mfma_f32_16x16x32_bf16 v[252:255], v[140:143], v[28:31], v[252:255]
  s_add_u32 s51, s58, 36864
  buffer_load_dwordx4 v[24:27], v1, s[24:27], s51 offen sc1
  s_add_u32 s51, s59, 36864
  buffer_load_dwordx4 v[28:31], v1, s[24:27], s51 offen sc1
  s_waitcnt vmcnt(7)
  v_mfma_f32_16x16x32_bf16 v[224:227], v[144:147], v[32:35], v[224:227]
  v_mfma_f32_16x16x32_bf16 v[228:231], v[148:151], v[32:35], v[228:231]
  v_mfma_f32_16x16x32_bf16 v[232:235], v[152:155], v[32:35], v[232:235]
  v_mfma_f32_16x16x32_bf16 v[236:239], v[156:159], v[32:35], v[236:239]
  s_waitcnt vmcnt(6)
  v_mfma_f32_16x16x32_bf16 v[240:243], v[144:147], v[36:39], v[240:243]
  v_mfma_f32_16x16x32_bf16 v[244:247], v[148:151], v[36:39], v[244:247]
  v_mfma_f32_16x16x32_bf16 v[248:251], v[152:155], v[36:39], v[248:251]
  v_mfma_f32_16x16x32_bf16 v[252:255], v[156:159], v[36:39], v[252:255]
  s_add_u32 s51, s58, 40960
  buffer_load_dwordx4 v[32:35], v1, s[24:27], s51 offen sc1
  s_add_u32 s51, s59, 40960
  buffer_load_dwordx4 v[36:39], v1, s[24:27], s51 offen sc1
  s_waitcnt vmcnt(7)
  v_mfma_f32_16x16x32_bf16 v[224:227], v[160:163], v[40:43], v[224:227]
  v_mfma_f32_16x16x32_bf16 v[228:231], v[164:167], v[40:43], v[228:231]
  v_mfma_f32_16x16x32_bf16 v[232:235], v[168:171], v[40:43], v[232:235]
  v_mfma_f32_16x16x32_bf16 v[236:239], v[172:175], v[40:43], v[236:239]
  s_waitcnt vmcnt(6)
  v_mfma_f32_16x16x32_bf16 v[240:243], v[160:163], v[44:47], v[240:243]
  v_mfma_f32_16x16x32_bf16 v[244:247], v[164:167], v[44:47], v[244:247]
  v_mfma_f32_16x16x32_bf16 v[248:251], v[168:171], v[44:47], v[248:251]
  v_mfma_f32_16x16x32_bf16 v[252:255], v[172:175], v[44:47], v[252:255]
  s_waitcnt vmcnt(5)
  v_mfma_f32_16x16x32_bf16 v[224:227], v[176:179], v[16:19], v[224:227]
  v_mfma_f32_16x16x32_bf16 v[228:231], v[180:183], v[16:19], v[228:231]
  v_mfma_f32_16x16x32_bf16 v[232:235], v[184:187], v[16:19], v[232:235]
  v_mfma_f32_16x16x32_bf16 v[236:239], v[188:191], v[16:19], v[236:239]
  s_waitcnt vmcnt(4)
  v_mfma_f32_16x16x32_bf16 v[240:243], v[176:179], v[20:23], v[240:243]
  v_mfma_f32_16x16x32_bf16 v[244:247], v[180:183], v[20:23], v[244:247]
  v_mfma_f32_16x16x32_bf16 v[248:251], v[184:187], v[20:23], v[248:251]
  v_mfma_f32_16x16x32_bf16 v[252:255], v[188:191], v[20:23], v[252:255]
  s_waitcnt vmcnt(3)
  v_mfma_f32_16x16x32_bf16 v[224:227], v[192:195], v[24:27], v[224:227]
  v_mfma_f32_16x16x32_bf16 v[228:231], v[196:199], v[24:27], v[228:231]
  v_mfma_f32_16x16x32_bf16 v[232:235], v[200:203], v[24:27], v[232:235]
  v_mfma_f32_16x16x32_bf16 v[236:239], v[204:207], v[24:27], v[236:239]
  s_waitcnt vmcnt(2)
  v_mfma_f32_16x16x32_bf16 v[240:243], v[192:195], v[28:31], v[240:243]
  v_mfma_f32_16x16x32_bf16 v[244:247], v[196:199], v[28:31], v[244:247]
  v_mfma_f32_16x16x32_bf16 v[248:251], v[200:203], v[28:31], v[248:251]
  v_mfma_f32_16x16x32_bf16 v[252:255], v[204:207], v[28:31], v[252:255]
  s_waitcnt vmcnt(1)
  v_mfma_f32_16x16x32_bf16 v[224:227], v[208:211], v[32:35], v[224:227]
  v_mfma_f32_16x16x32_bf16 v[228:231], v[212:215], v[32:35], v[228:231]
  v_mfma_f32_16x16x32_bf16 v[232:235], v[216:219], v[32:35], v[232:235]
  v_mfma_f32_16x16x32_bf16 v[236:239], v[220:223], v[32:35], v[236:239]
  s_waitcnt vmcnt(0)
  v_mfma_f32_16x16x32_bf16 v[240:243], v[208:211], v[36:39], v[240:243]
  v_mfma_f32_16x16x32_bf16 v[244:247], v[212:215], v[36:39], v[244:247]
  v_mfma_f32_16x16x32_bf16 v[248:251], v[216:219], v[36:39], v[248:251]
  v_mfma_f32_16x16x32_bf16 v[252:255], v[220:223], v[36:39], v[252:255]
L_sequential_preLN__ssm_conv_h3__dense_activation_silu__prompt_kernel_81:
  s_mul_i32 s53, s42, 6144
  v_add_u32 v48, s53, v1
  s_xor_b32 s53, s42, 2
  s_mul_i32 s53, s53, 6144
  s_add_u32 s53, s53, 0
  v_add_u32 v49, s53, v1
  s_xor_b32 s53, s42, 4
  s_mul_i32 s53, s53, 6144
  s_add_u32 s53, s53, 2048
  v_add_u32 v50, s53, v1
  s_xor_b32 s53, s42, 6
  s_mul_i32 s53, s53, 6144
  s_add_u32 s53, s53, 4096
  v_add_u32 v51, s53, v1
  ds_write_b128 v48, v[224:227] offset:2048
  ds_write_b128 v48, v[228:231] offset:3072
  ds_write_b128 v48, v[248:251] offset:0
  ds_write_b128 v48, v[252:255] offset:1024
  ds_write_b128 v48, v[240:243] offset:4096
  ds_write_b128 v48, v[244:247] offset:5120
  v_and_b32 v52, 15, v2
  v_lshlrev_b32 v52, 10, v52
  v_lshl_add_u32 v52, v11, 5, v52
  v_lshrrev_b32 v53, 1, v8
  v_lshl_add_u32 v52, v53, 4, v52
  s_lshl_b32 s58, s98, 16
  s_lshl_b32 s59, s66, 14
  s_add_u32 s58, s58, s59
  s_lshl_b32 s59, s99, 7
  s_add_u32 s58, s58, s59
  v_lshlrev_b32 v56, 16, v12
  v_and_b32 v57, s79, v12
  v_lshlrev_b32 v58, 16, v13
  v_and_b32 v59, s79, v13
  v_lshlrev_b32 v60, 16, v14
  v_and_b32 v61, s79, v14
  v_lshlrev_b32 v62, 16, v15
  v_and_b32 v63, s79, v15
  v_add_f32 v56, v56, v232
  v_add_f32 v57, v57, v233
  v_add_f32 v58, v58, v234
  v_add_f32 v59, v59, v235
  v_add_f32 v60, v60, v236
  v_add_f32 v61, v61, v237
  v_add_f32 v62, v62, v238
  v_add_f32 v63, v63, v239
  s_waitcnt lgkmcnt(0)
  s_barrier
  ds_read_b128 v[64:67], v49
  ds_read_b128 v[68:71], v49 offset:1024
  ds_read_b128 v[72:75], v50
  ds_read_b128 v[76:79], v50 offset:1024
  ds_read_b128 v[80:83], v51
  ds_read_b128 v[84:87], v51 offset:1024
  s_waitcnt lgkmcnt(4)
  v_pk_add_f32 v[56:57], v[56:57], v[64:65]
  v_pk_add_f32 v[58:59], v[58:59], v[66:67]
  v_pk_add_f32 v[60:61], v[60:61], v[68:69]
  v_pk_add_f32 v[62:63], v[62:63], v[70:71]
  s_waitcnt lgkmcnt(2)
  v_pk_add_f32 v[56:57], v[56:57], v[72:73]
  v_pk_add_f32 v[58:59], v[58:59], v[74:75]
  v_pk_add_f32 v[60:61], v[60:61], v[76:77]
  v_pk_add_f32 v[62:63], v[62:63], v[78:79]
  s_waitcnt lgkmcnt(0)
  v_pk_add_f32 v[56:57], v[56:57], v[80:81]
  v_pk_add_f32 v[58:59], v[58:59], v[82:83]
  v_pk_add_f32 v[60:61], v[60:61], v[84:85]
  v_pk_add_f32 v[62:63], v[62:63], v[86:87]
  v_cvt_pk_bf16_f32 v88, v56, v57
  v_cvt_pk_bf16_f32 v89, v58, v59
  v_cvt_pk_bf16_f32 v90, v60, v61
  v_cvt_pk_bf16_f32 v91, v62, v63
  s_nop 1
  v_permlane16_swap_b32 v88, v90
  v_permlane16_swap_b32 v89, v91
  s_nop 0
  buffer_store_dwordx4 v[88:91], v52, s[16:19], s58 offen offset:64
L_fin:
L_end:
  s_endpgm
.section .rodata,"a"
.p2align 6
.amdhsa_kernel sequential_preLN__ssm_conv_h3__dense_activation_silu__prompt_kernel
  .amdhsa_next_free_vgpr 256
  .amdhsa_next_free_sgpr 102
  .amdhsa_accum_offset 256
  .amdhsa_group_segment_fixed_size 0
  .amdhsa_kernarg_size 96
  .amdhsa_user_sgpr_count 2
  .amdhsa_user_sgpr_kernarg_segment_ptr 1
  .amdhsa_system_sgpr_workgroup_id_x 1
  .amdhsa_float_denorm_mode_32 3
  .amdhsa_float_denorm_mode_16_64 3
.end_amdhsa_kernel
```
